```python
import torch

def _softmax(x, axis=-1):
    return torch.softmax(x, dim=axis)
def _gelu(x):
    return torch.nn.functional.gelu(x, approximate="tanh")
def _silu(x):
    return torch.nn.functional.silu(x)
def _sigmoid(x):
    return torch.sigmoid(x)
def _layernorm(x, axis=-1, eps=1e-5):
    m = x.mean(dim=axis, keepdim=True)
    v = x.var(dim=axis, keepdim=True, unbiased=False)
    return (x - m) / torch.sqrt(v + eps)
def _scatter_add(tgt, idx, src, axis=0):
    return tgt.clone().index_add_(axis, idx, src)
def _segment_sum(src, seg, n):
    out = torch.zeros((n,) + src.shape[1:], dtype=src.dtype)
    return out.index_add_(0, seg, src)
def _pad(x, pw):
    flat = tuple(v for pair in reversed(pw) for v in pair)
    return torch.nn.functional.pad(x, flat)

kernel_name = 'parallel_sum__linear_attn_block__mixer_s_mlp__prompt'

def setup_inputs():

    _w = (lambda a: (lambda t: t.to(torch.bfloat16) if t.is_floating_point() else t)(torch.as_tensor(a)))
    def _A_setup():
        B, S, D = 1, 2048, 512
        return {
            "x": _w((lambda *s: torch.randn(*s, dtype=torch.bfloat16) * 0.05)(B, S, D)),
            "wqkv": _w((lambda *s: torch.randn(*s, dtype=torch.bfloat16) * 0.4)(D, 3 * D)),
            "wo": _w((lambda *s: torch.randn(*s, dtype=torch.bfloat16) * 0.4)(D, D)),
        }
    _A_in = _A_setup()

    def _B_setup():
        B, S, D, F = 1, 2048, 512, 1376
        return {
            "x":  _w((lambda *s: torch.randn(*s, dtype=torch.bfloat16) * 0.05)(B, S, D)),
            "w1": _w((lambda *s: torch.randn(*s, dtype=torch.bfloat16) * 3.2)(D, D) * (D ** -0.5)),
            "w2": _w((lambda *s: torch.randn(*s, dtype=torch.bfloat16) * 3.2)(D, D) * (D ** -0.5)),
            "w3": _w((lambda *s: torch.randn(*s, dtype=torch.bfloat16) * 3.2)(D, F) * (D ** -0.5)),
            "w4": _w((lambda *s: torch.randn(*s, dtype=torch.bfloat16) * 3.2)(F, D) * (F ** -0.5)),
        }
    _B_in = _B_setup()

    return {
        "A_x": _A_in["x"],
        "A_wqkv": _A_in["wqkv"],
        "A_wo": _A_in["wo"],
        "B_x": _B_in["x"],
        "B_w1": _B_in["w1"],
        "B_w2": _B_in["w2"],
        "B_w3": _B_in["w3"],
        "B_w4": _B_in["w4"],
    }

def reference(A_x, A_wqkv, A_wo, B_x, B_w1, B_w2, B_w3, B_w4):
    def _A_ref(x, wqkv, wo):
        B, S, D = x.shape
        H = 32; Dh = D // H
        qkv = (lambda x, *d: x.permute(*d))((x @ wqkv).reshape(B, S, 3, H, Dh), 2, 0, 3, 1, 4)
        q, k, v = qkv[0], qkv[1], qkv[2]
        phi = lambda t: torch.where(t > 0, t + 1, torch.exp(t)) + 1e-6
        pq, pk = phi(q), phi(k)
        kv = torch.einsum("bhsd,bhse->bhde", pk, v)
        z = torch.einsum("bhsd->bhd", pk)
        num = torch.einsum("bhqd,bhde->bhqe", pq, kv)
        den = torch.einsum("bhqd,bhd->bhq", pq, z)[..., None] + 1e-6
        o = num / den
        return (lambda x, *d: x.permute(*d))(o, 0, 2, 1, 3).reshape(B, S, D) @ wo

    def _B_ref(x, w1, w2, w3, w4):
        B, S, D = x.shape
        h = _gelu(_layernorm(x, axis=-1) @ w1)
        c = D // 4
        g0 = _pad(h[:, :, 0*c:1*c], ((0, 0), (1, 0), (0, 0)))[:, :S, :]
        g1 = _pad(h[:, :, 1*c:2*c], ((0, 0), (0, 1), (0, 0)))[:, 1:, :]
        g2 = _pad(h[:, :, 2*c:3*c], ((0, 0), (2, 0), (0, 0)))[:, :S, :]
        g3 = _pad(h[:, :, 3*c:   ], ((0, 0), (0, 2), (0, 0)))[:, 2:, :]
        hs = torch.concatenate([g0, g1, g2, g3], axis=-1) @ w2
        x1 = x + hs
        h2 = _gelu(_layernorm(x1, axis=-1) @ w3) @ w4
        return x1 + h2

    x = A_x
    xn = _layernorm(x, axis=-1)
    return x + _A_ref(xn, A_wqkv, A_wo) + _B_ref(xn, B_w1, B_w2, B_w3, B_w4)
```

```asm
; @launch grid=(256,1,1) block=(384,1,1) lds=163840
.amdgcn_target "amdgcn-amd-amdhsa--gfx950"
.text
.globl parallel_sum__linear_attn_block__mixer_s_mlp__prompt_kernel
.p2align 8
.type parallel_sum__linear_attn_block__mixer_s_mlp__prompt_kernel,@function
parallel_sum__linear_attn_block__mixer_s_mlp__prompt_kernel:
  s_cmp_ge_u32 s2, 0x100
  s_cbranch_scc1 Lexit
  s_load_dwordx16 s[80:95], s[0:1], 0
  s_load_dwordx4 s[96:99], s[0:1], 64
  s_load_dwordx2 s[100:101], s[0:1], 80
  s_getpc_b64 s[72:73]
Lpc_first:
  s_sub_u32 s72, s72, (Lpc_first - parallel_sum__linear_attn_block__mixer_s_mlp__prompt_kernel)
  s_subb_u32 s73, s73, 0
  v_lshlrev_b32 v20, 7, v0
  v_min_u32 v20, (Lcode_end - parallel_sum__linear_attn_block__mixer_s_mlp__prompt_kernel - 4), v20
  global_load_dword v19, v20, s[72:73]
  s_and_b32 s58, s2, 6
  s_lshl_b32 s58, s58, 2
  s_lshr_b32 s59, s2, 3
  s_lshr_b32 s44, s59, 2
  s_add_u32 s44, s44, s58
  s_and_b32 s45, s59, 3
  s_and_b32 s58, s2, 1
  s_lshl_b32 s58, s58, 2
  s_add_u32 s45, s45, s58
  s_xor_b32 s45, s45, 0
  v_lshrrev_b32 v13, 6, v0
  v_and_b32 v1, 63, v0
  v_readfirstlane_b32 s46, v13
  v_lshlrev_b32 v2, 4, v1
  s_waitcnt lgkmcnt(0)
  s_mov_b32 s4, s80
  s_mov_b32 s5, s81
  s_mov_b32 s6, 2097152
  s_mov_b32 s7, 0x00020000
  s_mov_b32 s16, s88
  s_mov_b32 s17, s89
  s_mov_b32 s18, 524288
  s_mov_b32 s19, 0x00020000
  s_mov_b32 s36, s100
  s_mov_b32 s37, s101
  s_mov_b32 s38, 20971520
  s_mov_b32 s39, 0x00020000
  s_mov_b32 s8, s82
  s_mov_b32 s9, s83
  s_mov_b32 s10, 1572864
  s_mov_b32 s11, 0x00020000
  s_mov_b32 s40, s98
  s_mov_b32 s41, s99
  s_mov_b32 s42, 256
  s_mov_b32 s43, 0x00020000
  s_mov_b32 s20, s90
  s_mov_b32 s21, s91
  s_mov_b32 s22, 524288
  s_mov_b32 s23, 0x00020000
  s_mov_b32 s24, s92
  s_mov_b32 s25, s93
  s_mov_b32 s26, 1409024
  s_mov_b32 s27, 0x00020000
  s_mov_b32 s12, s84
  s_mov_b32 s13, s85
  s_mov_b32 s14, 524288
  s_mov_b32 s15, 0x00020000
  s_mov_b32 s28, s94
  s_mov_b32 s29, s95
  s_mov_b32 s30, 1409024
  s_mov_b32 s31, 0x00020000
  s_mov_b32 s32, s96
  s_mov_b32 s33, s97
  s_mov_b32 s34, 2097152
  s_mov_b32 s35, 0x00020000
  s_xor_b32 s82, s45, 2
  s_xor_b32 s83, s45, 1
  s_cmp_lt_u32 s46, 4
  s_cbranch_scc1 Lcompute
  s_sub_u32 s47, s46, 4
  s_lshl_b32 s60, s44, 1
  s_add_u32 s60, s60, s47
  s_lshl_b32 s57, s44, 16
  s_lshl_b32 s58, s47, 15
  s_add_u32 s57, s57, s58
  s_mul_i32 s58, s47, 33280
  s_add_u32 m0, s58, 81920
  s_mul_i32 s58, s2, 16
  s_lshl_b32 s59, s47, 5
  s_add_u32 s58, s58, s59
  v_and_b32 v30, 31, v1
  v_add_u32 v31, s59, v30
  v_add_u32 v30, s58, v30
  v_cmp_gt_u32 vcc, 16, v31
  v_lshlrev_b32 v30, 7, v30
  v_add_u32 v30, 0, v30
  v_mov_b32 v31, 0x80000000
  v_cndmask_b32 v30, v31, v30, vcc
  buffer_load_dword v19, v30, s[16:19], 0 offen
  s_mul_i32 s58, s2, 16
  s_lshl_b32 s59, s47, 5
  s_add_u32 s58, s58, s59
  v_and_b32 v30, 31, v1
  v_add_u32 v31, s59, v30
  v_add_u32 v30, s58, v30
  v_cmp_gt_u32 vcc, 16, v31
  v_lshrrev_b32 v31, 3, v30
  v_mul_u32_u24 v31, 3072, v31
  v_and_b32 v30, 7, v30
  v_lshl_add_u32 v30, v30, 7, v31
  v_add_u32 v30, 0, v30
  v_mov_b32 v31, 0x80000000
  v_cndmask_b32 v30, v31, v30, vcc
  buffer_load_dword v19, v30, s[8:11], 0 offen
  s_nop 0
  buffer_load_dwordx4 v2, s[4:7], s57 offen lds
  s_addk_i32 m0, 1040
  s_addk_i32 s57, 1024
  buffer_load_dwordx4 v2, s[4:7], s57 offen lds
  s_lshl_b32 s49, s47, 13
  s_lshl_b32 s58, s45, 7
  s_lshl_b32 s50, s47, 16
  s_add_u32 s50, s50, s58
  s_mul_i32 s51, s47, 196608
  s_lshl_b32 s59, s83, 7
  s_add_u32 s51, s51, s59
  s_lshl_b32 s84, s47, 16
  s_lshl_b32 s59, s82, 7
  s_add_u32 s84, s84, s59
  s_mul_i32 s52, s47, 176128
  s_mul_i32 s59, s45, 384
  s_add_u32 s52, s52, s59
  s_mul_i32 s53, s47, 196608
  s_add_u32 s53, s53, s58
  s_lshl_b32 s54, s60, 15
  s_mul_i32 s55, s60, 98304
  s_mul_i32 s81, s45, 196608
  s_lshl_b32 s59, s47, 13
  s_add_u32 s81, s81, s59
  s_mov_b32 s85, s81
  s_lshl_b32 s88, s45, 16
  s_add_u32 s88, s88, s59
  v_lshrrev_b32 v20, 3, v1
  v_and_b32 v21, 7, v1
  v_lshrrev_b32 v22, 1, v20
  v_and_b32 v22, 1, v22
  v_lshlrev_b32 v22, 2, v22
  v_xor_b32 v21, v21, v22
  v_lshlrev_b32 v21, 4, v21
  v_lshl_add_u32 v3, v20, 10, v21
  v_mul_u32_u24 v4, 0xc00, v20
  v_add_u32 v4, v4, v21
  v_mul_u32_u24 v5, 0xac0, v20
  v_add_u32 v5, v5, v21
  s_addk_i32 m0, 1040
  s_addk_i32 s57, 1024
  buffer_load_dwordx4 v2, s[4:7], s57 offen lds
  s_addk_i32 m0, 1040
  s_addk_i32 s57, 1024
  buffer_load_dwordx4 v2, s[4:7], s57 offen lds
  s_addk_i32 m0, 1040
  s_addk_i32 s57, 1024
  buffer_load_dwordx4 v2, s[4:7], s57 offen lds
  s_addk_i32 m0, 1040
  s_addk_i32 s57, 1024
  buffer_load_dwordx4 v2, s[4:7], s57 offen lds
  s_addk_i32 m0, 1040
  s_addk_i32 s57, 1024
  buffer_load_dwordx4 v2, s[4:7], s57 offen lds
  s_addk_i32 m0, 1040
  s_addk_i32 s57, 1024
  buffer_load_dwordx4 v2, s[4:7], s57 offen lds
  s_addk_i32 m0, 1040
  s_addk_i32 s57, 1024
  buffer_load_dwordx4 v2, s[4:7], s57 offen lds
  s_addk_i32 m0, 1040
  s_addk_i32 s57, 1024
  buffer_load_dwordx4 v2, s[4:7], s57 offen lds
  s_addk_i32 m0, 1040
  s_addk_i32 s57, 1024
  buffer_load_dwordx4 v2, s[4:7], s57 offen lds
  s_addk_i32 m0, 1040
  s_addk_i32 s57, 1024
  buffer_load_dwordx4 v2, s[4:7], s57 offen lds
  s_addk_i32 m0, 1040
  s_addk_i32 s57, 1024
  buffer_load_dwordx4 v2, s[4:7], s57 offen lds
  s_addk_i32 m0, 1040
  s_addk_i32 s57, 1024
  buffer_load_dwordx4 v2, s[4:7], s57 offen lds
  s_addk_i32 m0, 1040
  s_addk_i32 s57, 1024
  buffer_load_dwordx4 v2, s[4:7], s57 offen lds
  s_addk_i32 m0, 1040
  s_addk_i32 s57, 1024
  buffer_load_dwordx4 v2, s[4:7], s57 offen lds
  s_addk_i32 m0, 1040
  s_addk_i32 s57, 1024
  buffer_load_dwordx4 v2, s[4:7], s57 offen lds
  s_addk_i32 m0, 1040
  s_addk_i32 s57, 1024
  buffer_load_dwordx4 v2, s[4:7], s57 offen lds
  s_addk_i32 m0, 1040
  s_addk_i32 s57, 1024
  buffer_load_dwordx4 v2, s[4:7], s57 offen lds
  s_addk_i32 m0, 1040
  s_addk_i32 s57, 1024
  buffer_load_dwordx4 v2, s[4:7], s57 offen lds
  s_addk_i32 m0, 1040
  s_addk_i32 s57, 1024
  buffer_load_dwordx4 v2, s[4:7], s57 offen lds
  s_addk_i32 m0, 1040
  s_addk_i32 s57, 1024
  buffer_load_dwordx4 v2, s[4:7], s57 offen lds
  s_addk_i32 m0, 1040
  s_addk_i32 s57, 1024
  buffer_load_dwordx4 v2, s[4:7], s57 offen lds
  s_addk_i32 m0, 1040
  s_addk_i32 s57, 1024
  buffer_load_dwordx4 v2, s[4:7], s57 offen lds
  s_addk_i32 m0, 1040
  s_addk_i32 s57, 1024
  buffer_load_dwordx4 v2, s[4:7], s57 offen lds
  s_addk_i32 m0, 1040
  s_addk_i32 s57, 1024
  buffer_load_dwordx4 v2, s[4:7], s57 offen lds
  s_addk_i32 m0, 1040
  s_addk_i32 s57, 1024
  buffer_load_dwordx4 v2, s[4:7], s57 offen lds
  s_addk_i32 m0, 1040
  s_addk_i32 s57, 1024
  buffer_load_dwordx4 v2, s[4:7], s57 offen lds
  s_addk_i32 m0, 1040
  s_addk_i32 s57, 1024
  buffer_load_dwordx4 v2, s[4:7], s57 offen lds
  s_addk_i32 m0, 1040
  s_addk_i32 s57, 1024
  buffer_load_dwordx4 v2, s[4:7], s57 offen lds
  s_addk_i32 m0, 1040
  s_addk_i32 s57, 1024
  buffer_load_dwordx4 v2, s[4:7], s57 offen lds
  s_addk_i32 m0, 1040
  s_addk_i32 s57, 1024
  buffer_load_dwordx4 v2, s[4:7], s57 offen lds
  s_add_u32 m0, s49, 0
  s_add_u32 s57, s84, 0
  buffer_load_dwordx4 v3, s[16:19], s57 offen lds
  s_addk_i32 m0, 1024
  s_addk_i32 s57, 8192
  buffer_load_dwordx4 v3, s[16:19], s57 offen lds
  s_addk_i32 m0, 1024
  s_addk_i32 s57, 8192
  buffer_load_dwordx4 v3, s[16:19], s57 offen lds
  s_addk_i32 m0, 1024
  s_addk_i32 s57, 8192
  buffer_load_dwordx4 v3, s[16:19], s57 offen lds
  s_addk_i32 m0, 1024
  s_addk_i32 s57, 8192
  buffer_load_dwordx4 v3, s[16:19], s57 offen lds
  s_addk_i32 m0, 1024
  s_addk_i32 s57, 8192
  buffer_load_dwordx4 v3, s[16:19], s57 offen lds
  s_addk_i32 m0, 1024
  s_addk_i32 s57, 8192
  buffer_load_dwordx4 v3, s[16:19], s57 offen lds
  s_addk_i32 m0, 1024
  s_addk_i32 s57, 8192
  buffer_load_dwordx4 v3, s[16:19], s57 offen lds
  s_add_u32 m0, s49, 16384
  s_add_u32 s57, s84, 131072
  buffer_load_dwordx4 v3, s[16:19], s57 offen lds
  s_addk_i32 m0, 1024
  s_addk_i32 s57, 8192
  buffer_load_dwordx4 v3, s[16:19], s57 offen lds
  s_addk_i32 m0, 1024
  s_addk_i32 s57, 8192
  buffer_load_dwordx4 v3, s[16:19], s57 offen lds
  s_addk_i32 m0, 1024
  s_addk_i32 s57, 8192
  buffer_load_dwordx4 v3, s[16:19], s57 offen lds
  s_addk_i32 m0, 1024
  s_addk_i32 s57, 8192
  buffer_load_dwordx4 v3, s[16:19], s57 offen lds
  s_addk_i32 m0, 1024
  s_addk_i32 s57, 8192
  buffer_load_dwordx4 v3, s[16:19], s57 offen lds
  s_addk_i32 m0, 1024
  s_addk_i32 s57, 8192
  buffer_load_dwordx4 v3, s[16:19], s57 offen lds
  s_addk_i32 m0, 1024
  s_addk_i32 s57, 8192
  buffer_load_dwordx4 v3, s[16:19], s57 offen lds
  s_waitcnt vmcnt(16)
  s_barrier
  s_mul_i32 s58, s2, 16
  s_lshl_b32 s59, s47, 5
  s_add_u32 s58, s58, s59
  v_and_b32 v30, 31, v1
  v_add_u32 v31, s59, v30
  v_add_u32 v30, s58, v30
  v_cmp_gt_u32 vcc, 16, v31
  v_lshlrev_b32 v30, 7, v30
  v_add_u32 v30, 0, v30
  v_mov_b32 v31, 0x80000000
  v_cndmask_b32 v30, v31, v30, vcc
  buffer_load_dword v19, v30, s[20:23], 0 offen
  s_add_u32 m0, s49, 32768
  s_add_u32 s57, s84, 262144
  buffer_load_dwordx4 v3, s[16:19], s57 offen lds
  s_addk_i32 m0, 1024
  s_addk_i32 s57, 8192
  buffer_load_dwordx4 v3, s[16:19], s57 offen lds
  s_addk_i32 m0, 1024
  s_addk_i32 s57, 8192
  buffer_load_dwordx4 v3, s[16:19], s57 offen lds
  s_addk_i32 m0, 1024
  s_addk_i32 s57, 8192
  buffer_load_dwordx4 v3, s[16:19], s57 offen lds
  s_addk_i32 m0, 1024
  s_addk_i32 s57, 8192
  buffer_load_dwordx4 v3, s[16:19], s57 offen lds
  s_addk_i32 m0, 1024
  s_addk_i32 s57, 8192
  buffer_load_dwordx4 v3, s[16:19], s57 offen lds
  s_addk_i32 m0, 1024
  s_addk_i32 s57, 8192
  buffer_load_dwordx4 v3, s[16:19], s57 offen lds
  s_addk_i32 m0, 1024
  s_addk_i32 s57, 8192
  buffer_load_dwordx4 v3, s[16:19], s57 offen lds
  v_and_b32 v10, 7, v1
  v_lshlrev_b32 v10, 2, v10
  v_and_b32 v20, 31, v1
  v_lshlrev_b32 v11, 2, v20
  s_lshl_b32 s59, s45, 7
  v_add_u32 v8, s59, v11
  s_lshl_b32 s59, s83, 7
  v_add_u32 v11, s59, v11
  v_lshrrev_b32 v21, 3, v1
  v_min_u32 v21, 2, v21
  v_add_u32 v21, s44, v21
  v_max_u32 v21, 1, v21
  v_min_u32 v21, 32, v21
  v_subrev_u32 v21, 1, v21
  v_lshl_add_u32 v9, v21, 7, v10
  s_lshl_b32 s58, s44, 7
  v_add_u32 v10, s58, v10
  v_and_b32 v12, 0x3e, v1
  v_lshlrev_b32 v12, 2, v12
  v_mov_b32 v13, 1
  s_cmp_eq_u32 s47, 0
  s_cselect_b32 s58, 0, 0x80000000
  s_cselect_b32 s59, -1, 0
  v_or_b32 v12, s58, v12
  v_and_b32 v13, s59, v13
  s_barrier
  s_add_u32 m0, s49, 49152
  s_add_u32 s57, s84, 393216
  buffer_load_dwordx4 v3, s[16:19], s57 offen lds
  s_addk_i32 m0, 1024
  s_addk_i32 s57, 8192
  buffer_load_dwordx4 v3, s[16:19], s57 offen lds
  s_addk_i32 m0, 1024
  s_addk_i32 s57, 8192
  buffer_load_dwordx4 v3, s[16:19], s57 offen lds
  s_addk_i32 m0, 1024
  s_addk_i32 s57, 8192
  buffer_load_dwordx4 v3, s[16:19], s57 offen lds
  s_addk_i32 m0, 1024
  s_addk_i32 s57, 8192
  buffer_load_dwordx4 v3, s[16:19], s57 offen lds
  s_addk_i32 m0, 1024
  s_addk_i32 s57, 8192
  buffer_load_dwordx4 v3, s[16:19], s57 offen lds
  s_addk_i32 m0, 1024
  s_addk_i32 s57, 8192
  buffer_load_dwordx4 v3, s[16:19], s57 offen lds
  s_addk_i32 m0, 1024
  s_addk_i32 s57, 8192
  buffer_load_dwordx4 v3, s[16:19], s57 offen lds
  s_mul_i32 s58, s2, 16
  s_lshl_b32 s59, s47, 5
  s_add_u32 s58, s58, s59
  v_and_b32 v30, 31, v1
  v_add_u32 v31, s59, v30
  v_add_u32 v30, s58, v30
  v_cmp_gt_u32 vcc, 16, v31
  v_lshrrev_b32 v31, 3, v30
  v_mul_u32_u24 v31, 3072, v31
  v_and_b32 v30, 7, v30
  v_lshl_add_u32 v30, v30, 7, v31
  v_add_u32 v30, 1024, v30
  v_mov_b32 v31, 0x80000000
  v_cndmask_b32 v30, v31, v30, vcc
  buffer_load_dword v19, v30, s[8:11], 0 offen
  s_waitcnt vmcnt(26)
  s_barrier
  s_add_u32 m0, s49, 65536
  s_add_u32 s57, s51, 0
  buffer_load_dwordx4 v4, s[8:11], s57 offen lds
  s_addk_i32 m0, 1024
  s_addk_i32 s57, 24576
  buffer_load_dwordx4 v4, s[8:11], s57 offen lds
  s_addk_i32 m0, 1024
  s_addk_i32 s57, 24576
  buffer_load_dwordx4 v4, s[8:11], s57 offen lds
  s_addk_i32 m0, 1024
  s_addk_i32 s57, 24576
  buffer_load_dwordx4 v4, s[8:11], s57 offen lds
  s_addk_i32 m0, 1024
  s_addk_i32 s57, 24576
  buffer_load_dwordx4 v4, s[8:11], s57 offen lds
  s_addk_i32 m0, 1024
  s_addk_i32 s57, 24576
  buffer_load_dwordx4 v4, s[8:11], s57 offen lds
  s_addk_i32 m0, 1024
  s_addk_i32 s57, 24576
  buffer_load_dwordx4 v4, s[8:11], s57 offen lds
  s_addk_i32 m0, 1024
  s_addk_i32 s57, 24576
  buffer_load_dwordx4 v4, s[8:11], s57 offen lds
  s_add_u32 m0, s49, 81920
  s_add_u32 s57, s51, 393216
  buffer_load_dwordx4 v4, s[8:11], s57 offen lds
  s_waitcnt vmcnt(27)
  s_barrier
  buffer_load_dword v32, v12, s[40:43], 0 offen sc1
  s_addk_i32 m0, 1024
  s_addk_i32 s57, 24576
  buffer_load_dwordx4 v4, s[8:11], s57 offen lds
  s_addk_i32 m0, 1024
  s_addk_i32 s57, 24576
  buffer_load_dwordx4 v4, s[8:11], s57 offen lds
  s_addk_i32 m0, 1024
  s_addk_i32 s57, 24576
  buffer_load_dwordx4 v4, s[8:11], s57 offen lds
  s_addk_i32 m0, 1024
  s_addk_i32 s57, 24576
  buffer_load_dwordx4 v4, s[8:11], s57 offen lds
  s_addk_i32 m0, 1024
  s_addk_i32 s57, 24576
  buffer_load_dwordx4 v4, s[8:11], s57 offen lds
  s_addk_i32 m0, 1024
  s_addk_i32 s57, 24576
  buffer_load_dwordx4 v4, s[8:11], s57 offen lds
  s_addk_i32 m0, 1024
  s_addk_i32 s57, 24576
  buffer_load_dwordx4 v4, s[8:11], s57 offen lds
  s_add_u32 m0, s49, 98304
  s_add_u32 s57, s51, 786432
  buffer_load_dwordx4 v4, s[8:11], s57 offen lds
  s_addk_i32 m0, 1024
  s_addk_i32 s57, 24576
  buffer_load_dwordx4 v4, s[8:11], s57 offen lds
  s_waitcnt vmcnt(28)
  s_barrier
  s_addk_i32 m0, 1024
  s_addk_i32 s57, 24576
  buffer_load_dwordx4 v4, s[8:11], s57 offen lds
  s_addk_i32 m0, 1024
  s_addk_i32 s57, 24576
  buffer_load_dwordx4 v4, s[8:11], s57 offen lds
  s_addk_i32 m0, 1024
  s_addk_i32 s57, 24576
  buffer_load_dwordx4 v4, s[8:11], s57 offen lds
  s_addk_i32 m0, 1024
  s_addk_i32 s57, 24576
  buffer_load_dwordx4 v4, s[8:11], s57 offen lds
  s_addk_i32 m0, 1024
  s_addk_i32 s57, 24576
  buffer_load_dwordx4 v4, s[8:11], s57 offen lds
  s_addk_i32 m0, 1024
  s_addk_i32 s57, 24576
  buffer_load_dwordx4 v4, s[8:11], s57 offen lds
  s_add_u32 m0, s49, 114688
  s_add_u32 s57, s51, 1179648
  buffer_load_dwordx4 v4, s[8:11], s57 offen lds
  s_addk_i32 m0, 1024
  s_addk_i32 s57, 24576
  buffer_load_dwordx4 v4, s[8:11], s57 offen lds
  s_addk_i32 m0, 1024
  s_addk_i32 s57, 24576
  buffer_load_dwordx4 v4, s[8:11], s57 offen lds
  s_waitcnt vmcnt(29)
  s_barrier
  s_waitcnt vmcnt(18)
  v_cmp_le_u32 vcc, v13, v32
  s_cmp_eq_u64 vcc, -1
  s_cbranch_scc0 Lslow_1
Ldone_2:
  s_addk_i32 m0, 1024
  s_addk_i32 s57, 24576
  buffer_load_dwordx4 v4, s[8:11], s57 offen lds
  s_addk_i32 m0, 1024
  s_addk_i32 s57, 24576
  buffer_load_dwordx4 v4, s[8:11], s57 offen lds
  s_addk_i32 m0, 1024
  s_addk_i32 s57, 24576
  buffer_load_dwordx4 v4, s[8:11], s57 offen lds
  s_addk_i32 m0, 1024
  s_addk_i32 s57, 24576
  buffer_load_dwordx4 v4, s[8:11], s57 offen lds
  s_addk_i32 m0, 1024
  s_addk_i32 s57, 24576
  buffer_load_dwordx4 v4, s[8:11], s57 offen lds
  s_add_u32 m0, s49, 131072
  s_add_u32 s57, s51, 1024
  buffer_load_dwordx4 v4, s[8:11], s57 offen lds
  s_addk_i32 m0, 1024
  s_addk_i32 s57, 24576
  buffer_load_dwordx4 v4, s[8:11], s57 offen lds
  s_addk_i32 m0, 1024
  s_addk_i32 s57, 24576
  buffer_load_dwordx4 v4, s[8:11], s57 offen lds
  s_addk_i32 m0, 1024
  s_addk_i32 s57, 24576
  buffer_load_dwordx4 v4, s[8:11], s57 offen lds
  s_barrier
  s_addk_i32 m0, 1024
  s_addk_i32 s57, 24576
  buffer_load_dwordx4 v4, s[8:11], s57 offen lds
  s_addk_i32 m0, 1024
  s_addk_i32 s57, 24576
  buffer_load_dwordx4 v4, s[8:11], s57 offen lds
  s_addk_i32 m0, 1024
  s_addk_i32 s57, 24576
  buffer_load_dwordx4 v4, s[8:11], s57 offen lds
  s_addk_i32 m0, 1024
  s_addk_i32 s57, 24576
  buffer_load_dwordx4 v4, s[8:11], s57 offen lds
  s_add_u32 m0, s49, 0
  s_add_u32 s57, s51, 394240
  buffer_load_dwordx4 v4, s[8:11], s57 offen lds
  s_addk_i32 m0, 1024
  s_addk_i32 s57, 24576
  buffer_load_dwordx4 v4, s[8:11], s57 offen lds
  s_addk_i32 m0, 1024
  s_addk_i32 s57, 24576
  buffer_load_dwordx4 v4, s[8:11], s57 offen lds
  s_addk_i32 m0, 1024
  s_addk_i32 s57, 24576
  buffer_load_dwordx4 v4, s[8:11], s57 offen lds
  s_addk_i32 m0, 1024
  s_addk_i32 s57, 24576
  buffer_load_dwordx4 v4, s[8:11], s57 offen lds
  s_addk_i32 m0, 1024
  s_addk_i32 s57, 24576
  buffer_load_dwordx4 v4, s[8:11], s57 offen lds
  s_addk_i32 m0, 1024
  s_addk_i32 s57, 24576
  buffer_load_dwordx4 v4, s[8:11], s57 offen lds
  s_addk_i32 m0, 1024
  s_addk_i32 s57, 24576
  buffer_load_dwordx4 v4, s[8:11], s57 offen lds
  s_add_u32 m0, s49, 16384
  s_add_u32 s57, s51, 787456
  buffer_load_dwordx4 v4, s[8:11], s57 offen lds
  s_addk_i32 m0, 1024
  s_addk_i32 s57, 24576
  buffer_load_dwordx4 v4, s[8:11], s57 offen lds
  s_addk_i32 m0, 1024
  s_addk_i32 s57, 24576
  buffer_load_dwordx4 v4, s[8:11], s57 offen lds
  s_addk_i32 m0, 1024
  s_addk_i32 s57, 24576
  buffer_load_dwordx4 v4, s[8:11], s57 offen lds
  s_addk_i32 m0, 1024
  s_addk_i32 s57, 24576
  buffer_load_dwordx4 v4, s[8:11], s57 offen lds
  s_addk_i32 m0, 1024
  s_addk_i32 s57, 24576
  buffer_load_dwordx4 v4, s[8:11], s57 offen lds
  s_addk_i32 m0, 1024
  s_addk_i32 s57, 24576
  buffer_load_dwordx4 v4, s[8:11], s57 offen lds
  s_addk_i32 m0, 1024
  s_addk_i32 s57, 24576
  buffer_load_dwordx4 v4, s[8:11], s57 offen lds
  s_add_u32 m0, s49, 32768
  s_add_u32 s57, s51, 1180672
  buffer_load_dwordx4 v4, s[8:11], s57 offen lds
  s_barrier
  s_addk_i32 m0, 1024
  s_addk_i32 s57, 24576
  buffer_load_dwordx4 v4, s[8:11], s57 offen lds
  s_addk_i32 m0, 1024
  s_addk_i32 s57, 24576
  buffer_load_dwordx4 v4, s[8:11], s57 offen lds
  s_addk_i32 m0, 1024
  s_addk_i32 s57, 24576
  buffer_load_dwordx4 v4, s[8:11], s57 offen lds
  s_addk_i32 m0, 1024
  s_addk_i32 s57, 24576
  buffer_load_dwordx4 v4, s[8:11], s57 offen lds
  s_addk_i32 m0, 1024
  s_addk_i32 s57, 24576
  buffer_load_dwordx4 v4, s[8:11], s57 offen lds
  s_addk_i32 m0, 1024
  s_addk_i32 s57, 24576
  buffer_load_dwordx4 v4, s[8:11], s57 offen lds
  s_addk_i32 m0, 1024
  s_addk_i32 s57, 24576
  buffer_load_dwordx4 v4, s[8:11], s57 offen lds
  s_add_u32 m0, s49, 49152
  s_add_u32 s57, s50, 0
  buffer_load_dwordx4 v3, s[20:23], s57 offen lds
  s_addk_i32 m0, 1024
  s_addk_i32 s57, 8192
  buffer_load_dwordx4 v3, s[20:23], s57 offen lds
  s_waitcnt vmcnt(50)
  s_barrier
  s_mul_i32 s58, s2, 16
  s_lshl_b32 s59, s47, 5
  s_add_u32 s58, s58, s59
  v_and_b32 v30, 31, v1
  v_add_u32 v31, s59, v30
  v_add_u32 v30, s58, v30
  v_cmp_gt_u32 vcc, 16, v31
  v_lshrrev_b32 v31, 3, v30
  v_mul_u32_u24 v31, 3072, v31
  v_and_b32 v30, 7, v30
  v_lshl_add_u32 v30, v30, 7, v31
  v_add_u32 v30, 2048, v30
  v_mov_b32 v31, 0x80000000
  v_cndmask_b32 v30, v31, v30, vcc
  buffer_load_dword v19, v30, s[8:11], 0 offen
  s_addk_i32 m0, 1024
  s_addk_i32 s57, 8192
  buffer_load_dwordx4 v3, s[20:23], s57 offen lds
  s_addk_i32 m0, 1024
  s_addk_i32 s57, 8192
  buffer_load_dwordx4 v3, s[20:23], s57 offen lds
  s_addk_i32 m0, 1024
  s_addk_i32 s57, 8192
  buffer_load_dwordx4 v3, s[20:23], s57 offen lds
  s_addk_i32 m0, 1024
  s_addk_i32 s57, 8192
  buffer_load_dwordx4 v3, s[20:23], s57 offen lds
  s_addk_i32 m0, 1024
  s_addk_i32 s57, 8192
  buffer_load_dwordx4 v3, s[20:23], s57 offen lds
  s_addk_i32 m0, 1024
  s_addk_i32 s57, 8192
  buffer_load_dwordx4 v3, s[20:23], s57 offen lds
  s_add_u32 m0, s49, 65536
  s_add_u32 s57, s50, 262144
  buffer_load_dwordx4 v3, s[20:23], s57 offen lds
  s_addk_i32 m0, 1024
  s_addk_i32 s57, 8192
  buffer_load_dwordx4 v3, s[20:23], s57 offen lds
  s_addk_i32 m0, 1024
  s_addk_i32 s57, 8192
  buffer_load_dwordx4 v3, s[20:23], s57 offen lds
  s_waitcnt vmcnt(52)
  s_barrier
  s_addk_i32 m0, 1024
  s_addk_i32 s57, 8192
  buffer_load_dwordx4 v3, s[20:23], s57 offen lds
  s_addk_i32 m0, 1024
  s_addk_i32 s57, 8192
  buffer_load_dwordx4 v3, s[20:23], s57 offen lds
  s_addk_i32 m0, 1024
  s_addk_i32 s57, 8192
  buffer_load_dwordx4 v3, s[20:23], s57 offen lds
  s_addk_i32 m0, 1024
  s_addk_i32 s57, 8192
  buffer_load_dwordx4 v3, s[20:23], s57 offen lds
  s_addk_i32 m0, 1024
  s_addk_i32 s57, 8192
  buffer_load_dwordx4 v3, s[20:23], s57 offen lds
  s_add_u32 m0, s49, 81920
  s_add_u32 s57, s50, 393216
  buffer_load_dwordx4 v3, s[20:23], s57 offen lds
  s_addk_i32 m0, 1024
  s_addk_i32 s57, 8192
  buffer_load_dwordx4 v3, s[20:23], s57 offen lds
  s_addk_i32 m0, 1024
  s_addk_i32 s57, 8192
  buffer_load_dwordx4 v3, s[20:23], s57 offen lds
  s_waitcnt vmcnt(52)
  s_addk_i32 m0, 1024
  s_addk_i32 s57, 8192
  buffer_load_dwordx4 v3, s[20:23], s57 offen lds
  s_barrier
  s_addk_i32 m0, 1024
  s_addk_i32 s57, 8192
  buffer_load_dwordx4 v3, s[20:23], s57 offen lds
  s_addk_i32 m0, 1024
  s_addk_i32 s57, 8192
  buffer_load_dwordx4 v3, s[20:23], s57 offen lds
  s_addk_i32 m0, 1024
  s_addk_i32 s57, 8192
  buffer_load_dwordx4 v3, s[20:23], s57 offen lds
  s_addk_i32 m0, 1024
  s_addk_i32 s57, 8192
  buffer_load_dwordx4 v3, s[20:23], s57 offen lds
  s_add_u32 m0, s49, 98304
  s_add_u32 s57, s50, 131072
  buffer_load_dwordx4 v3, s[20:23], s57 offen lds
  s_addk_i32 m0, 1024
  s_addk_i32 s57, 8192
  buffer_load_dwordx4 v3, s[20:23], s57 offen lds
  s_addk_i32 m0, 1024
  s_addk_i32 s57, 8192
  buffer_load_dwordx4 v3, s[20:23], s57 offen lds
  s_waitcnt vmcnt(52)
  s_addk_i32 m0, 1024
  s_addk_i32 s57, 8192
  buffer_load_dwordx4 v3, s[20:23], s57 offen lds
  s_addk_i32 m0, 1024
  s_addk_i32 s57, 8192
  buffer_load_dwordx4 v3, s[20:23], s57 offen lds
  s_barrier
  s_addk_i32 m0, 1024
  s_addk_i32 s57, 8192
  buffer_load_dwordx4 v3, s[20:23], s57 offen lds
  s_addk_i32 m0, 1024
  s_addk_i32 s57, 8192
  buffer_load_dwordx4 v3, s[20:23], s57 offen lds
  s_addk_i32 m0, 1024
  s_addk_i32 s57, 8192
  buffer_load_dwordx4 v3, s[20:23], s57 offen lds
  s_barrier
  s_waitcnt vmcnt(49)
  s_barrier
  s_waitcnt vmcnt(41)
  s_barrier
  s_waitcnt vmcnt(33)
  s_barrier
  s_mov_b32 s76, 12713984
  buffer_load_dword v33, v9, s[36:39], s76 offen sc1
  s_waitcnt vmcnt(0)
  v_cmp_eq_u32 vcc, 1, v33
  s_mov_b32 s72, 0xc0c
  s_mov_b32 s73, 0x0
  s_and_b64 vcc, vcc, s[72:73]
  s_cmp_eq_u64 vcc, s[72:73]
  s_cbranch_scc0 Lslow_4
Ldone_5:
  v_and_b32 v7, 31, v1
  s_lshl_b32 s77, s60, 5
  s_add_u32 s77, s77, 4294967295
  v_add_u32 v7, s77, v7
  v_cmp_gt_u32 vcc, 0x800, v7
  v_lshrrev_b32 v6, 5, v7
  v_lshlrev_b32 v6, 15, v6
  v_and_b32 v7, 31, v7
  v_lshl_add_u32 v6, v7, 4, v6
  v_and_b32 v7, 32, v1
  v_lshl_add_u32 v6, v7, 4, v6
  v_mov_b32 v7, 0x80000000
  v_cndmask_b32 v6, v7, v6, vcc
  s_mov_b32 s77, 0
  s_add_u32 m0, s49, 114688
  s_add_u32 s57, s77, 0
  buffer_load_dwordx4 v6, s[36:39], s57 offen offset:0 sc1 lds
  buffer_load_dwordx4 v6, s[36:39], s57 offen offset:1024 sc1 lds
  buffer_load_dwordx4 v6, s[36:39], s57 offen offset:2048 sc1 lds
  buffer_load_dwordx4 v6, s[36:39], s57 offen offset:3072 sc1 lds
  s_add_u32 m0, s49, 118784
  s_add_u32 s57, s77, 4096
  buffer_load_dwordx4 v6, s[36:39], s57 offen offset:0 sc1 lds
  buffer_load_dwordx4 v6, s[36:39], s57 offen offset:1024 sc1 lds
  buffer_load_dwordx4 v6, s[36:39], s57 offen offset:2048 sc1 lds
  buffer_load_dwordx4 v6, s[36:39], s57 offen offset:3072 sc1 lds
  v_cmp_eq_u32 vcc, 1, v33
  s_mov_b32 s72, 0xc0c0
  s_mov_b32 s73, 0x0
  s_and_b64 vcc, vcc, s[72:73]
  s_cmp_eq_u64 vcc, s[72:73]
  s_cbranch_scc0 Lslow_7
Ldone_8:
  v_and_b32 v7, 31, v1
  s_lshl_b32 s77, s60, 5
  s_add_u32 s77, s77, 4294967294
  v_add_u32 v7, s77, v7
  v_cmp_gt_u32 vcc, 0x800, v7
  v_lshrrev_b32 v6, 5, v7
  v_lshlrev_b32 v6, 15, v6
  v_and_b32 v7, 31, v7
  v_lshl_add_u32 v6, v7, 4, v6
  v_and_b32 v7, 32, v1
  v_lshl_add_u32 v6, v7, 4, v6
  v_mov_b32 v7, 0x80000000
  v_cndmask_b32 v6, v7, v6, vcc
  s_mov_b32 s77, 0
  s_add_u32 m0, s49, 131072
  s_add_u32 s57, s77, 16384
  buffer_load_dwordx4 v6, s[36:39], s57 offen offset:0 sc1 lds
  buffer_load_dwordx4 v6, s[36:39], s57 offen offset:1024 sc1 lds
  buffer_load_dwordx4 v6, s[36:39], s57 offen offset:2048 sc1 lds
  buffer_load_dwordx4 v6, s[36:39], s57 offen offset:3072 sc1 lds
  s_add_u32 m0, s49, 135168
  s_add_u32 s57, s77, 20480
  buffer_load_dwordx4 v6, s[36:39], s57 offen offset:0 sc1 lds
  buffer_load_dwordx4 v6, s[36:39], s57 offen offset:1024 sc1 lds
  buffer_load_dwordx4 v6, s[36:39], s57 offen offset:2048 sc1 lds
  buffer_load_dwordx4 v6, s[36:39], s57 offen offset:3072 sc1 lds
  v_cmp_eq_u32 vcc, 1, v33
  s_mov_b32 s72, 0x303000
  s_mov_b32 s73, 0x0
  s_and_b64 vcc, vcc, s[72:73]
  s_cmp_eq_u64 vcc, s[72:73]
  s_cbranch_scc0 Lslow_10
Ldone_11:
  v_and_b32 v7, 31, v1
  s_lshl_b32 s77, s60, 5
  s_add_u32 s77, s77, 2
  v_add_u32 v7, s77, v7
  v_cmp_gt_u32 vcc, 0x800, v7
  v_lshrrev_b32 v6, 5, v7
  v_lshlrev_b32 v6, 15, v6
  v_and_b32 v7, 31, v7
  v_lshl_add_u32 v6, v7, 4, v6
  v_and_b32 v7, 32, v1
  v_lshl_add_u32 v6, v7, 4, v6
  v_mov_b32 v7, 0x80000000
  v_cndmask_b32 v6, v7, v6, vcc
  s_mov_b32 s77, 0
  s_add_u32 m0, s49, 0
  s_add_u32 s57, s77, 24576
  buffer_load_dwordx4 v6, s[36:39], s57 offen offset:0 sc1 lds
  buffer_load_dwordx4 v6, s[36:39], s57 offen offset:1024 sc1 lds
  buffer_load_dwordx4 v6, s[36:39], s57 offen offset:2048 sc1 lds
  buffer_load_dwordx4 v6, s[36:39], s57 offen offset:3072 sc1 lds
  s_add_u32 m0, s49, 4096
  s_add_u32 s57, s77, 28672
  buffer_load_dwordx4 v6, s[36:39], s57 offen offset:0 sc1 lds
  buffer_load_dwordx4 v6, s[36:39], s57 offen offset:1024 sc1 lds
  buffer_load_dwordx4 v6, s[36:39], s57 offen offset:2048 sc1 lds
  buffer_load_dwordx4 v6, s[36:39], s57 offen offset:3072 sc1 lds
  s_waitcnt vmcnt(16)
  s_barrier
  v_cmp_eq_u32 vcc, 1, v33
  s_mov_b32 s72, 0x30300
  s_mov_b32 s73, 0x0
  s_and_b64 vcc, vcc, s[72:73]
  s_cmp_eq_u64 vcc, s[72:73]
  s_cbranch_scc0 Lslow_13
Ldone_14:
  v_and_b32 v7, 31, v1
  s_lshl_b32 s77, s60, 5
  s_add_u32 s77, s77, 1
  v_add_u32 v7, s77, v7
  v_cmp_gt_u32 vcc, 0x800, v7
  v_lshrrev_b32 v6, 5, v7
  v_lshlrev_b32 v6, 15, v6
  v_and_b32 v7, 31, v7
  v_lshl_add_u32 v6, v7, 4, v6
  v_and_b32 v7, 32, v1
  v_lshl_add_u32 v6, v7, 4, v6
  v_mov_b32 v7, 0x80000000
  v_cndmask_b32 v6, v7, v6, vcc
  s_mov_b32 s77, 0
  s_add_u32 m0, s49, 16384
  s_add_u32 s57, s77, 8192
  buffer_load_dwordx4 v6, s[36:39], s57 offen offset:0 sc1 lds
  buffer_load_dwordx4 v6, s[36:39], s57 offen offset:1024 sc1 lds
  buffer_load_dwordx4 v6, s[36:39], s57 offen offset:2048 sc1 lds
  buffer_load_dwordx4 v6, s[36:39], s57 offen offset:3072 sc1 lds
  s_add_u32 m0, s49, 20480
  s_add_u32 s57, s77, 12288
  buffer_load_dwordx4 v6, s[36:39], s57 offen offset:0 sc1 lds
  buffer_load_dwordx4 v6, s[36:39], s57 offen offset:1024 sc1 lds
  buffer_load_dwordx4 v6, s[36:39], s57 offen offset:2048 sc1 lds
  buffer_load_dwordx4 v6, s[36:39], s57 offen offset:3072 sc1 lds
  s_add_u32 m0, s49, 32768
  s_add_u32 s57, s51, 2048
  buffer_load_dwordx4 v4, s[8:11], s57 offen lds
  s_addk_i32 m0, 1024
  s_addk_i32 s57, 24576
  buffer_load_dwordx4 v4, s[8:11], s57 offen lds
  s_addk_i32 m0, 1024
  s_addk_i32 s57, 24576
  buffer_load_dwordx4 v4, s[8:11], s57 offen lds
  s_addk_i32 m0, 1024
  s_addk_i32 s57, 24576
  buffer_load_dwordx4 v4, s[8:11], s57 offen lds
  s_addk_i32 m0, 1024
  s_addk_i32 s57, 24576
  buffer_load_dwordx4 v4, s[8:11], s57 offen lds
  s_addk_i32 m0, 1024
  s_addk_i32 s57, 24576
  buffer_load_dwordx4 v4, s[8:11], s57 offen lds
  s_addk_i32 m0, 1024
  s_addk_i32 s57, 24576
  buffer_load_dwordx4 v4, s[8:11], s57 offen lds
  s_addk_i32 m0, 1024
  s_addk_i32 s57, 24576
  buffer_load_dwordx4 v4, s[8:11], s57 offen lds
  s_waitcnt vmcnt(24)
  s_barrier
  s_add_u32 m0, s49, 49152
  s_add_u32 s57, s51, 395264
  buffer_load_dwordx4 v4, s[8:11], s57 offen lds
  s_addk_i32 m0, 1024
  s_addk_i32 s57, 24576
  buffer_load_dwordx4 v4, s[8:11], s57 offen lds
  s_addk_i32 m0, 1024
  s_addk_i32 s57, 24576
  buffer_load_dwordx4 v4, s[8:11], s57 offen lds
  s_addk_i32 m0, 1024
  s_addk_i32 s57, 24576
  buffer_load_dwordx4 v4, s[8:11], s57 offen lds
  s_addk_i32 m0, 1024
  s_addk_i32 s57, 24576
  buffer_load_dwordx4 v4, s[8:11], s57 offen lds
  s_addk_i32 m0, 1024
  s_addk_i32 s57, 24576
  buffer_load_dwordx4 v4, s[8:11], s57 offen lds
  s_addk_i32 m0, 1024
  s_addk_i32 s57, 24576
  buffer_load_dwordx4 v4, s[8:11], s57 offen lds
  s_addk_i32 m0, 1024
  s_addk_i32 s57, 24576
  buffer_load_dwordx4 v4, s[8:11], s57 offen lds
  s_waitcnt vmcnt(24)
  s_barrier
  s_mov_b32 s76, 12742656
  buffer_load_dword v40, v8, s[36:39], s76 offen sc1
  s_add_u32 m0, s49, 114688
  s_add_u32 s57, s51, 788480
  buffer_load_dwordx4 v4, s[8:11], s57 offen lds
  s_addk_i32 m0, 1024
  s_addk_i32 s57, 24576
  buffer_load_dwordx4 v4, s[8:11], s57 offen lds
  s_addk_i32 m0, 1024
  s_addk_i32 s57, 24576
  buffer_load_dwordx4 v4, s[8:11], s57 offen lds
  s_addk_i32 m0, 1024
  s_addk_i32 s57, 24576
  buffer_load_dwordx4 v4, s[8:11], s57 offen lds
  s_addk_i32 m0, 1024
  s_addk_i32 s57, 24576
  buffer_load_dwordx4 v4, s[8:11], s57 offen lds
  s_addk_i32 m0, 1024
  s_addk_i32 s57, 24576
  buffer_load_dwordx4 v4, s[8:11], s57 offen lds
  s_addk_i32 m0, 1024
  s_addk_i32 s57, 24576
  buffer_load_dwordx4 v4, s[8:11], s57 offen lds
  s_addk_i32 m0, 1024
  s_addk_i32 s57, 24576
  buffer_load_dwordx4 v4, s[8:11], s57 offen lds
  s_waitcnt vmcnt(25)
  s_barrier
  s_add_u32 m0, s49, 65536
  s_add_u32 s57, s51, 1181696
  buffer_load_dwordx4 v4, s[8:11], s57 offen lds
  s_addk_i32 m0, 1024
  s_addk_i32 s57, 24576
  buffer_load_dwordx4 v4, s[8:11], s57 offen lds
  s_addk_i32 m0, 1024
  s_addk_i32 s57, 24576
  buffer_load_dwordx4 v4, s[8:11], s57 offen lds
  s_addk_i32 m0, 1024
  s_addk_i32 s57, 24576
  buffer_load_dwordx4 v4, s[8:11], s57 offen lds
  s_addk_i32 m0, 1024
  s_addk_i32 s57, 24576
  buffer_load_dwordx4 v4, s[8:11], s57 offen lds
  s_addk_i32 m0, 1024
  s_addk_i32 s57, 24576
  buffer_load_dwordx4 v4, s[8:11], s57 offen lds
  s_addk_i32 m0, 1024
  s_addk_i32 s57, 24576
  buffer_load_dwordx4 v4, s[8:11], s57 offen lds
  s_addk_i32 m0, 1024
  s_addk_i32 s57, 24576
  buffer_load_dwordx4 v4, s[8:11], s57 offen lds
  s_barrier
  s_waitcnt vmcnt(16)
  v_cmp_ne_u32 vcc, 0, v40
  s_cmp_eq_u64 vcc, -1
  s_cbranch_scc0 Lslow_16
Ldone_17:
  s_add_u32 m0, s49, 81920
  s_add_u32 s57, s81, 14680064
  buffer_load_dwordx4 v2, s[36:39], s57 offen offset:0 sc1 lds
  buffer_load_dwordx4 v2, s[36:39], s57 offen offset:1024 sc1 lds
  buffer_load_dwordx4 v2, s[36:39], s57 offen offset:2048 sc1 lds
  buffer_load_dwordx4 v2, s[36:39], s57 offen offset:3072 sc1 lds
  s_add_u32 m0, s49, 86016
  s_add_u32 s57, s81, 14684160
  buffer_load_dwordx4 v2, s[36:39], s57 offen offset:0 sc1 lds
  buffer_load_dwordx4 v2, s[36:39], s57 offen offset:1024 sc1 lds
  buffer_load_dwordx4 v2, s[36:39], s57 offen offset:2048 sc1 lds
  buffer_load_dwordx4 v2, s[36:39], s57 offen offset:3072 sc1 lds
  s_add_u32 m0, s49, 98304
  s_add_u32 s57, s81, 14712832
  buffer_load_dwordx4 v2, s[36:39], s57 offen offset:0 sc1 lds
  buffer_load_dwordx4 v2, s[36:39], s57 offen offset:1024 sc1 lds
  buffer_load_dwordx4 v2, s[36:39], s57 offen offset:2048 sc1 lds
  buffer_load_dwordx4 v2, s[36:39], s57 offen offset:3072 sc1 lds
  s_add_u32 m0, s49, 102400
  s_add_u32 s57, s81, 14716928
  buffer_load_dwordx4 v2, s[36:39], s57 offen offset:0 sc1 lds
  buffer_load_dwordx4 v2, s[36:39], s57 offen offset:1024 sc1 lds
  s_barrier
  buffer_load_dwordx4 v2, s[36:39], s57 offen offset:2048 sc1 lds
  buffer_load_dwordx4 v2, s[36:39], s57 offen offset:3072 sc1 lds
  s_barrier
  s_mul_i32 s58, s2, 43
  s_lshl_b32 s59, s47, 5
  s_add_u32 s58, s58, s59
  v_and_b32 v30, 31, v1
  v_add_u32 v31, s59, v30
  v_add_u32 v30, s58, v30
  v_cmp_gt_u32 vcc, 43, v31
  v_lshlrev_b32 v30, 7, v30
  v_add_u32 v30, 0, v30
  v_mov_b32 v31, 0x80000000
  v_cndmask_b32 v30, v31, v30, vcc
  buffer_load_dword v19, v30, s[28:31], 0 offen
  s_add_u32 m0, s49, 32768
  s_add_u32 s57, s81, 14729216
  buffer_load_dwordx4 v2, s[36:39], s57 offen offset:0 sc1 lds
  buffer_load_dwordx4 v2, s[36:39], s57 offen offset:1024 sc1 lds
  buffer_load_dwordx4 v2, s[36:39], s57 offen offset:2048 sc1 lds
  buffer_load_dwordx4 v2, s[36:39], s57 offen offset:3072 sc1 lds
  s_add_u32 m0, s49, 36864
  s_add_u32 s57, s81, 14733312
  buffer_load_dwordx4 v2, s[36:39], s57 offen offset:0 sc1 lds
  buffer_load_dwordx4 v2, s[36:39], s57 offen offset:1024 sc1 lds
  buffer_load_dwordx4 v2, s[36:39], s57 offen offset:2048 sc1 lds
  buffer_load_dwordx4 v2, s[36:39], s57 offen offset:3072 sc1 lds
  s_waitcnt vmcnt(33)
  s_barrier
  s_mul_i32 s58, s2, 16
  s_lshl_b32 s59, s47, 5
  s_add_u32 s58, s58, s59
  v_and_b32 v30, 31, v1
  v_add_u32 v31, s59, v30
  v_add_u32 v30, s58, v30
  v_cmp_gt_u32 vcc, 16, v31
  v_lshlrev_b32 v30, 7, v30
  v_add_u32 v30, 0, v30
  v_mov_b32 v31, 0x80000000
  v_cndmask_b32 v30, v31, v30, vcc
  buffer_load_dword v19, v30, s[12:15], 0 offen
  s_waitcnt vmcnt(26)
  s_barrier
  s_add_u32 m0, s49, 114688
  s_add_u32 s57, s81, 14696448
  buffer_load_dwordx4 v2, s[36:39], s57 offen offset:0 sc1 lds
  buffer_load_dwordx4 v2, s[36:39], s57 offen offset:1024 sc1 lds
  buffer_load_dwordx4 v2, s[36:39], s57 offen offset:2048 sc1 lds
  buffer_load_dwordx4 v2, s[36:39], s57 offen offset:3072 sc1 lds
  s_add_u32 m0, s49, 118784
  s_add_u32 s57, s81, 14700544
  buffer_load_dwordx4 v2, s[36:39], s57 offen offset:0 sc1 lds
  buffer_load_dwordx4 v2, s[36:39], s57 offen offset:1024 sc1 lds
  buffer_load_dwordx4 v2, s[36:39], s57 offen offset:2048 sc1 lds
  buffer_load_dwordx4 v2, s[36:39], s57 offen offset:3072 sc1 lds
  s_barrier
  s_mov_b32 s76, 12718080
  buffer_load_dword v34, v10, s[36:39], s76 offen sc1
  s_waitcnt vmcnt(0)
  v_cmp_eq_u32 vcc, 1, v34
  s_mov_b32 s72, 0x3
  s_mov_b32 s73, 0x0
  s_and_b64 vcc, vcc, s[72:73]
  s_cmp_eq_u64 vcc, s[72:73]
  s_cbranch_scc0 Lslow_19
Ldone_20:
  s_add_u32 m0, s49, 131072
  s_add_u32 s57, s54, 2097152
  buffer_load_dwordx4 v2, s[36:39], s57 offen offset:0 sc1 lds
  buffer_load_dwordx4 v2, s[36:39], s57 offen offset:1024 sc1 lds
  buffer_load_dwordx4 v2, s[36:39], s57 offen offset:2048 sc1 lds
  buffer_load_dwordx4 v2, s[36:39], s57 offen offset:3072 sc1 lds
  s_add_u32 m0, s49, 135168
  s_add_u32 s57, s54, 2101248
  buffer_load_dwordx4 v2, s[36:39], s57 offen offset:0 sc1 lds
  buffer_load_dwordx4 v2, s[36:39], s57 offen offset:1024 sc1 lds
  buffer_load_dwordx4 v2, s[36:39], s57 offen offset:2048 sc1 lds
  buffer_load_dwordx4 v2, s[36:39], s57 offen offset:3072 sc1 lds
  v_cmp_eq_u32 vcc, 1, v34
  s_mov_b32 s72, 0x30
  s_mov_b32 s73, 0x0
  s_and_b64 vcc, vcc, s[72:73]
  s_cmp_eq_u64 vcc, s[72:73]
  s_cbranch_scc0 Lslow_22
Ldone_23:
  s_add_u32 m0, s49, 0
  s_add_u32 s57, s54, 2113536
  buffer_load_dwordx4 v2, s[36:39], s57 offen offset:0 sc1 lds
  buffer_load_dwordx4 v2, s[36:39], s57 offen offset:1024 sc1 lds
  buffer_load_dwordx4 v2, s[36:39], s57 offen offset:2048 sc1 lds
  buffer_load_dwordx4 v2, s[36:39], s57 offen offset:3072 sc1 lds
  s_add_u32 m0, s49, 4096
  s_add_u32 s57, s54, 2117632
  buffer_load_dwordx4 v2, s[36:39], s57 offen offset:0 sc1 lds
  buffer_load_dwordx4 v2, s[36:39], s57 offen offset:1024 sc1 lds
  buffer_load_dwordx4 v2, s[36:39], s57 offen offset:2048 sc1 lds
  buffer_load_dwordx4 v2, s[36:39], s57 offen offset:3072 sc1 lds
  v_cmp_eq_u32 vcc, 1, v34
  s_mov_b32 s72, 0xc0
  s_mov_b32 s73, 0x0
  s_and_b64 vcc, vcc, s[72:73]
  s_cmp_eq_u64 vcc, s[72:73]
  s_cbranch_scc0 Lslow_25
Ldone_26:
  s_add_u32 m0, s49, 16384
  s_add_u32 s57, s54, 2121728
  buffer_load_dwordx4 v2, s[36:39], s57 offen offset:0 sc1 lds
  buffer_load_dwordx4 v2, s[36:39], s57 offen offset:1024 sc1 lds
  buffer_load_dwordx4 v2, s[36:39], s57 offen offset:2048 sc1 lds
  buffer_load_dwordx4 v2, s[36:39], s57 offen offset:3072 sc1 lds
  s_add_u32 m0, s49, 20480
  s_add_u32 s57, s54, 2125824
  buffer_load_dwordx4 v2, s[36:39], s57 offen offset:0 sc1 lds
  buffer_load_dwordx4 v2, s[36:39], s57 offen offset:1024 sc1 lds
  buffer_load_dwordx4 v2, s[36:39], s57 offen offset:2048 sc1 lds
  buffer_load_dwordx4 v2, s[36:39], s57 offen offset:3072 sc1 lds
  s_add_u32 m0, s49, 65536
  s_add_u32 s57, s81, 14745600
  buffer_load_dwordx4 v2, s[36:39], s57 offen offset:0 sc1 lds
  buffer_load_dwordx4 v2, s[36:39], s57 offen offset:1024 sc1 lds
  buffer_load_dwordx4 v2, s[36:39], s57 offen offset:2048 sc1 lds
  buffer_load_dwordx4 v2, s[36:39], s57 offen offset:3072 sc1 lds
  s_add_u32 m0, s49, 69632
  s_add_u32 s57, s81, 14749696
  buffer_load_dwordx4 v2, s[36:39], s57 offen offset:0 sc1 lds
  buffer_load_dwordx4 v2, s[36:39], s57 offen offset:1024 sc1 lds
  buffer_load_dwordx4 v2, s[36:39], s57 offen offset:2048 sc1 lds
  buffer_load_dwordx4 v2, s[36:39], s57 offen offset:3072 sc1 lds
  s_waitcnt vmcnt(24)
  s_barrier
  v_cmp_eq_u32 vcc, 1, v34
  s_mov_b32 s72, 0xc
  s_mov_b32 s73, 0x0
  s_and_b64 vcc, vcc, s[72:73]
  s_cmp_eq_u64 vcc, s[72:73]
  s_cbranch_scc0 Lslow_28
Ldone_29:
  s_add_u32 m0, s49, 49152
  s_add_u32 s57, s54, 2105344
  buffer_load_dwordx4 v2, s[36:39], s57 offen offset:0 sc1 lds
  buffer_load_dwordx4 v2, s[36:39], s57 offen offset:1024 sc1 lds
  buffer_load_dwordx4 v2, s[36:39], s57 offen offset:2048 sc1 lds
  buffer_load_dwordx4 v2, s[36:39], s57 offen offset:3072 sc1 lds
  s_add_u32 m0, s49, 53248
  s_add_u32 s57, s54, 2109440
  buffer_load_dwordx4 v2, s[36:39], s57 offen offset:0 sc1 lds
  buffer_load_dwordx4 v2, s[36:39], s57 offen offset:1024 sc1 lds
  buffer_load_dwordx4 v2, s[36:39], s57 offen offset:2048 sc1 lds
  buffer_load_dwordx4 v2, s[36:39], s57 offen offset:3072 sc1 lds
  s_lshl_b32 s58, s60, 12
  s_add_u32 s57, s58, 12845056
  s_lshl_b32 s59, s47, 12
  s_add_u32 m0, s59, 154112
  s_nop 0
  buffer_load_dwordx4 v2, s[36:39], s57 offen offset:0 sc1 lds
  buffer_load_dwordx4 v2, s[36:39], s57 offen offset:1024 sc1 lds
  buffer_load_dwordx4 v2, s[36:39], s57 offen offset:2048 sc1 lds
  buffer_load_dwordx4 v2, s[36:39], s57 offen offset:3072 sc1 lds
  s_waitcnt vmcnt(28)
  s_barrier
  s_add_u32 m0, s49, 131072
  s_add_u32 s57, s81, 14761984
  buffer_load_dwordx4 v2, s[36:39], s57 offen offset:0 sc1 lds
  buffer_load_dwordx4 v2, s[36:39], s57 offen offset:1024 sc1 lds
  buffer_load_dwordx4 v2, s[36:39], s57 offen offset:2048 sc1 lds
  buffer_load_dwordx4 v2, s[36:39], s57 offen offset:3072 sc1 lds
  s_add_u32 m0, s49, 135168
  s_add_u32 s57, s81, 14766080
  buffer_load_dwordx4 v2, s[36:39], s57 offen offset:0 sc1 lds
  buffer_load_dwordx4 v2, s[36:39], s57 offen offset:1024 sc1 lds
  buffer_load_dwordx4 v2, s[36:39], s57 offen offset:2048 sc1 lds
  buffer_load_dwordx4 v2, s[36:39], s57 offen offset:3072 sc1 lds
  s_add_u32 m0, s49, 81920
  s_add_u32 s57, s81, 14778368
  buffer_load_dwordx4 v2, s[36:39], s57 offen offset:0 sc1 lds
  s_waitcnt vmcnt(29)
  s_barrier
  buffer_load_dwordx4 v2, s[36:39], s57 offen offset:1024 sc1 lds
  buffer_load_dwordx4 v2, s[36:39], s57 offen offset:2048 sc1 lds
  buffer_load_dwordx4 v2, s[36:39], s57 offen offset:3072 sc1 lds
  s_add_u32 m0, s49, 86016
  s_add_u32 s57, s81, 14782464
  buffer_load_dwordx4 v2, s[36:39], s57 offen offset:0 sc1 lds
  buffer_load_dwordx4 v2, s[36:39], s57 offen offset:1024 sc1 lds
  buffer_load_dwordx4 v2, s[36:39], s57 offen offset:2048 sc1 lds
  buffer_load_dwordx4 v2, s[36:39], s57 offen offset:3072 sc1 lds
  s_add_u32 m0, s49, 0
  s_add_u32 s57, s81, 14794752
  buffer_load_dwordx4 v2, s[36:39], s57 offen offset:0 sc1 lds
  buffer_load_dwordx4 v2, s[36:39], s57 offen offset:1024 sc1 lds
  s_waitcnt vmcnt(22)
  s_barrier
  buffer_load_dwordx4 v2, s[36:39], s57 offen offset:2048 sc1 lds
  buffer_load_dwordx4 v2, s[36:39], s57 offen offset:3072 sc1 lds
  s_add_u32 m0, s49, 4096
  s_add_u32 s57, s81, 14798848
  buffer_load_dwordx4 v2, s[36:39], s57 offen offset:0 sc1 lds
  buffer_load_dwordx4 v2, s[36:39], s57 offen offset:1024 sc1 lds
  buffer_load_dwordx4 v2, s[36:39], s57 offen offset:2048 sc1 lds
  buffer_load_dwordx4 v2, s[36:39], s57 offen offset:3072 sc1 lds
  s_add_u32 m0, s49, 98304
  s_add_u32 s57, s81, 14811136
  buffer_load_dwordx4 v2, s[36:39], s57 offen offset:0 sc1 lds
  buffer_load_dwordx4 v2, s[36:39], s57 offen offset:1024 sc1 lds
  buffer_load_dwordx4 v2, s[36:39], s57 offen offset:2048 sc1 lds
  s_waitcnt vmcnt(27)
  s_barrier
  buffer_load_dwordx4 v2, s[36:39], s57 offen offset:3072 sc1 lds
  s_add_u32 m0, s49, 102400
  s_add_u32 s57, s81, 14815232
  buffer_load_dwordx4 v2, s[36:39], s57 offen offset:0 sc1 lds
  buffer_load_dwordx4 v2, s[36:39], s57 offen offset:1024 sc1 lds
  buffer_load_dwordx4 v2, s[36:39], s57 offen offset:2048 sc1 lds
  buffer_load_dwordx4 v2, s[36:39], s57 offen offset:3072 sc1 lds
  s_add_u32 m0, s49, 16384
  s_add_u32 s57, s81, 14827520
  buffer_load_dwordx4 v2, s[36:39], s57 offen offset:0 sc1 lds
  buffer_load_dwordx4 v2, s[36:39], s57 offen offset:1024 sc1 lds
  buffer_load_dwordx4 v2, s[36:39], s57 offen offset:2048 sc1 lds
  buffer_load_dwordx4 v2, s[36:39], s57 offen offset:3072 sc1 lds
  s_add_u32 m0, s49, 20480
  s_add_u32 s57, s81, 14831616
  buffer_load_dwordx4 v2, s[36:39], s57 offen offset:0 sc1 lds
  buffer_load_dwordx4 v2, s[36:39], s57 offen offset:1024 sc1 lds
  buffer_load_dwordx4 v2, s[36:39], s57 offen offset:2048 sc1 lds
  buffer_load_dwordx4 v2, s[36:39], s57 offen offset:3072 sc1 lds
  s_add_u32 m0, s49, 32768
  s_add_u32 s57, s81, 14843904
  buffer_load_dwordx4 v2, s[36:39], s57 offen offset:0 sc1 lds
  buffer_load_dwordx4 v2, s[36:39], s57 offen offset:1024 sc1 lds
  buffer_load_dwordx4 v2, s[36:39], s57 offen offset:2048 sc1 lds
  buffer_load_dwordx4 v2, s[36:39], s57 offen offset:3072 sc1 lds
  s_add_u32 m0, s49, 36864
  s_add_u32 s57, s81, 14848000
  buffer_load_dwordx4 v2, s[36:39], s57 offen offset:0 sc1 lds
  buffer_load_dwordx4 v2, s[36:39], s57 offen offset:1024 sc1 lds
  buffer_load_dwordx4 v2, s[36:39], s57 offen offset:2048 sc1 lds
  buffer_load_dwordx4 v2, s[36:39], s57 offen offset:3072 sc1 lds
  s_add_u32 m0, s49, 49152
  s_add_u32 s57, s81, 14860288
  buffer_load_dwordx4 v2, s[36:39], s57 offen offset:0 sc1 lds
  s_barrier
  buffer_load_dwordx4 v2, s[36:39], s57 offen offset:1024 sc1 lds
  buffer_load_dwordx4 v2, s[36:39], s57 offen offset:2048 sc1 lds
  buffer_load_dwordx4 v2, s[36:39], s57 offen offset:3072 sc1 lds
  s_add_u32 m0, s49, 53248
  s_add_u32 s57, s81, 14864384
  buffer_load_dwordx4 v2, s[36:39], s57 offen offset:0 sc1 lds
  buffer_load_dwordx4 v2, s[36:39], s57 offen offset:1024 sc1 lds
  buffer_load_dwordx4 v2, s[36:39], s57 offen offset:2048 sc1 lds
  buffer_load_dwordx4 v2, s[36:39], s57 offen offset:3072 sc1 lds
  s_add_u32 m0, s49, 114688
  s_add_u32 s57, s53, 0
  buffer_load_dwordx4 v3, s[28:31], s57 offen lds
  s_addk_i32 m0, 1024
  s_addk_i32 s57, 8192
  buffer_load_dwordx4 v3, s[28:31], s57 offen lds
  s_waitcnt vmcnt(50)
  s_barrier
  s_addk_i32 m0, 1024
  s_addk_i32 s57, 8192
  buffer_load_dwordx4 v3, s[28:31], s57 offen lds
  s_addk_i32 m0, 1024
  s_addk_i32 s57, 8192
  buffer_load_dwordx4 v3, s[28:31], s57 offen lds
  s_addk_i32 m0, 1024
  s_addk_i32 s57, 8192
  buffer_load_dwordx4 v3, s[28:31], s57 offen lds
  s_addk_i32 m0, 1024
  s_addk_i32 s57, 8192
  buffer_load_dwordx4 v3, s[28:31], s57 offen lds
  s_addk_i32 m0, 1024
  s_addk_i32 s57, 8192
  buffer_load_dwordx4 v3, s[28:31], s57 offen lds
  s_addk_i32 m0, 1024
  s_addk_i32 s57, 8192
  buffer_load_dwordx4 v3, s[28:31], s57 offen lds
  s_waitcnt vmcnt(48)
  s_barrier
  s_add_u32 m0, s49, 131072
  s_add_u32 s57, s53, 393216
  buffer_load_dwordx4 v3, s[28:31], s57 offen lds
  s_addk_i32 m0, 1024
  s_addk_i32 s57, 8192
  buffer_load_dwordx4 v3, s[28:31], s57 offen lds
  s_addk_i32 m0, 1024
  s_addk_i32 s57, 8192
  buffer_load_dwordx4 v3, s[28:31], s57 offen lds
  s_addk_i32 m0, 1024
  s_addk_i32 s57, 8192
  buffer_load_dwordx4 v3, s[28:31], s57 offen lds
  s_addk_i32 m0, 1024
  s_addk_i32 s57, 8192
  buffer_load_dwordx4 v3, s[28:31], s57 offen lds
  s_addk_i32 m0, 1024
  s_addk_i32 s57, 8192
  buffer_load_dwordx4 v3, s[28:31], s57 offen lds
  s_addk_i32 m0, 1024
  s_addk_i32 s57, 8192
  buffer_load_dwordx4 v3, s[28:31], s57 offen lds
  s_addk_i32 m0, 1024
  s_addk_i32 s57, 8192
  buffer_load_dwordx4 v3, s[28:31], s57 offen lds
  s_waitcnt vmcnt(48)
  s_barrier
  s_barrier
  s_add_u32 m0, s49, 0
  s_add_u32 s57, s53, 786432
  buffer_load_dwordx4 v3, s[28:31], s57 offen lds
  s_addk_i32 m0, 1024
  s_addk_i32 s57, 8192
  buffer_load_dwordx4 v3, s[28:31], s57 offen lds
  s_addk_i32 m0, 1024
  s_addk_i32 s57, 8192
  buffer_load_dwordx4 v3, s[28:31], s57 offen lds
  s_addk_i32 m0, 1024
  s_addk_i32 s57, 8192
  buffer_load_dwordx4 v3, s[28:31], s57 offen lds
  s_addk_i32 m0, 1024
  s_addk_i32 s57, 8192
  buffer_load_dwordx4 v3, s[28:31], s57 offen lds
  s_addk_i32 m0, 1024
  s_addk_i32 s57, 8192
  buffer_load_dwordx4 v3, s[28:31], s57 offen lds
  s_addk_i32 m0, 1024
  s_addk_i32 s57, 8192
  buffer_load_dwordx4 v3, s[28:31], s57 offen lds
  s_addk_i32 m0, 1024
  s_addk_i32 s57, 8192
  buffer_load_dwordx4 v3, s[28:31], s57 offen lds
  s_waitcnt vmcnt(48)
  s_barrier
  s_mov_b32 s76, 12726272
  buffer_load_dword v36, v10, s[36:39], s76 offen sc1
  s_waitcnt vmcnt(41)
  s_barrier
  s_waitcnt vmcnt(33)
  s_barrier
  s_add_u32 m0, s49, 16384
  s_add_u32 s57, s53, 1179648
  buffer_load_dwordx4 v3, s[28:31], s57 offen lds
  s_addk_i32 m0, 1024
  s_addk_i32 s57, 8192
  buffer_load_dwordx4 v3, s[28:31], s57 offen lds
  s_addk_i32 m0, 1024
  s_addk_i32 s57, 8192
  buffer_load_dwordx4 v3, s[28:31], s57 offen lds
  s_addk_i32 m0, 1024
  s_addk_i32 s57, 8192
  buffer_load_dwordx4 v3, s[28:31], s57 offen lds
  s_addk_i32 m0, 1024
  s_addk_i32 s57, 8192
  buffer_load_dwordx4 v3, s[28:31], s57 offen lds
  s_addk_i32 m0, 1024
  s_addk_i32 s57, 8192
  buffer_load_dwordx4 v3, s[28:31], s57 offen lds
  s_addk_i32 m0, 1024
  s_addk_i32 s57, 8192
  buffer_load_dwordx4 v3, s[28:31], s57 offen lds
  s_addk_i32 m0, 1024
  s_addk_i32 s57, 8192
  buffer_load_dwordx4 v3, s[28:31], s57 offen lds
  s_waitcnt vmcnt(33)
  s_barrier
  s_waitcnt vmcnt(8)
  v_cmp_eq_u32 vcc, 1, v36
  s_cmp_eq_u64 vcc, -1
  s_cbranch_scc0 Lslow_31
Ldone_32:
  s_add_u32 m0, s49, 65536
  s_add_u32 s57, s55, 6291456
  buffer_load_dwordx4 v2, s[36:39], s57 offen offset:0 sc1 lds
  buffer_load_dwordx4 v2, s[36:39], s57 offen offset:1024 sc1 lds
  buffer_load_dwordx4 v2, s[36:39], s57 offen offset:2048 sc1 lds
  buffer_load_dwordx4 v2, s[36:39], s57 offen offset:3072 sc1 lds
  s_add_u32 m0, s49, 69632
  s_add_u32 s57, s55, 6303744
  buffer_load_dwordx4 v2, s[36:39], s57 offen offset:0 sc1 lds
  buffer_load_dwordx4 v2, s[36:39], s57 offen offset:1024 sc1 lds
  buffer_load_dwordx4 v2, s[36:39], s57 offen offset:2048 sc1 lds
  buffer_load_dwordx4 v2, s[36:39], s57 offen offset:3072 sc1 lds
  s_add_u32 m0, s49, 81920
  s_add_u32 s57, s55, 6316032
  buffer_load_dwordx4 v2, s[36:39], s57 offen offset:0 sc1 lds
  s_barrier
  buffer_load_dwordx4 v2, s[36:39], s57 offen offset:1024 sc1 lds
  buffer_load_dwordx4 v2, s[36:39], s57 offen offset:2048 sc1 lds
  buffer_load_dwordx4 v2, s[36:39], s57 offen offset:3072 sc1 lds
  s_add_u32 m0, s49, 86016
  s_add_u32 s57, s55, 6328320
  buffer_load_dwordx4 v2, s[36:39], s57 offen offset:0 sc1 lds
  buffer_load_dwordx4 v2, s[36:39], s57 offen offset:1024 sc1 lds
  buffer_load_dwordx4 v2, s[36:39], s57 offen offset:2048 sc1 lds
  buffer_load_dwordx4 v2, s[36:39], s57 offen offset:3072 sc1 lds
  s_add_u32 m0, s49, 98304
  s_add_u32 s57, s55, 6340608
  buffer_load_dwordx4 v2, s[36:39], s57 offen offset:0 sc1 lds
  buffer_load_dwordx4 v2, s[36:39], s57 offen offset:1024 sc1 lds
  buffer_load_dwordx4 v2, s[36:39], s57 offen offset:2048 sc1 lds
  buffer_load_dwordx4 v2, s[36:39], s57 offen offset:3072 sc1 lds
  s_add_u32 m0, s49, 102400
  s_add_u32 s57, s55, 6352896
  buffer_load_dwordx4 v2, s[36:39], s57 offen offset:0 sc1 lds
  buffer_load_dwordx4 v2, s[36:39], s57 offen offset:1024 sc1 lds
  buffer_load_dwordx4 v2, s[36:39], s57 offen offset:2048 sc1 lds
  buffer_load_dwordx4 v2, s[36:39], s57 offen offset:3072 sc1 lds
  s_add_u32 m0, s49, 32768
  s_add_u32 s57, s55, 6365184
  buffer_load_dwordx4 v2, s[36:39], s57 offen offset:0 sc1 lds
  buffer_load_dwordx4 v2, s[36:39], s57 offen offset:1024 sc1 lds
  buffer_load_dwordx4 v2, s[36:39], s57 offen offset:2048 sc1 lds
  buffer_load_dwordx4 v2, s[36:39], s57 offen offset:3072 sc1 lds
  s_add_u32 m0, s49, 36864
  s_add_u32 s57, s55, 6377472
  buffer_load_dwordx4 v2, s[36:39], s57 offen offset:0 sc1 lds
  buffer_load_dwordx4 v2, s[36:39], s57 offen offset:1024 sc1 lds
  buffer_load_dwordx4 v2, s[36:39], s57 offen offset:2048 sc1 lds
  s_waitcnt vmcnt(23)
  s_barrier
  s_mov_b32 s76, 12730368
  buffer_load_dword v37, v10, s[36:39], s76 offen sc1
  s_mov_b32 s76, 12738560
  buffer_load_dword v39, v11, s[36:39], s76 offen sc1
  buffer_load_dwordx4 v2, s[36:39], s57 offen offset:3072 sc1 lds
  s_add_u32 m0, s49, 49152
  s_add_u32 s57, s53, 65536
  buffer_load_dwordx4 v3, s[28:31], s57 offen lds
  s_addk_i32 m0, 1024
  s_addk_i32 s57, 8192
  buffer_load_dwordx4 v3, s[28:31], s57 offen lds
  s_addk_i32 m0, 1024
  s_addk_i32 s57, 8192
  buffer_load_dwordx4 v3, s[28:31], s57 offen lds
  s_addk_i32 m0, 1024
  s_addk_i32 s57, 8192
  buffer_load_dwordx4 v3, s[28:31], s57 offen lds
  s_addk_i32 m0, 1024
  s_addk_i32 s57, 8192
  buffer_load_dwordx4 v3, s[28:31], s57 offen lds
  s_addk_i32 m0, 1024
  s_addk_i32 s57, 8192
  buffer_load_dwordx4 v3, s[28:31], s57 offen lds
  s_addk_i32 m0, 1024
  s_addk_i32 s57, 8192
  buffer_load_dwordx4 v3, s[28:31], s57 offen lds
  s_addk_i32 m0, 1024
  s_addk_i32 s57, 8192
  buffer_load_dwordx4 v3, s[28:31], s57 offen lds
  s_waitcnt vmcnt(26)
  s_barrier
  s_add_u32 m0, s49, 65536
  s_add_u32 s57, s53, 458752
  buffer_load_dwordx4 v3, s[28:31], s57 offen lds
  s_addk_i32 m0, 1024
  s_addk_i32 s57, 8192
  buffer_load_dwordx4 v3, s[28:31], s57 offen lds
  s_addk_i32 m0, 1024
  s_addk_i32 s57, 8192
  buffer_load_dwordx4 v3, s[28:31], s57 offen lds
  s_addk_i32 m0, 1024
  s_addk_i32 s57, 8192
  buffer_load_dwordx4 v3, s[28:31], s57 offen lds
  s_addk_i32 m0, 1024
  s_addk_i32 s57, 8192
  buffer_load_dwordx4 v3, s[28:31], s57 offen lds
  s_addk_i32 m0, 1024
  s_addk_i32 s57, 8192
  buffer_load_dwordx4 v3, s[28:31], s57 offen lds
  s_addk_i32 m0, 1024
  s_addk_i32 s57, 8192
  buffer_load_dwordx4 v3, s[28:31], s57 offen lds
  s_addk_i32 m0, 1024
  s_addk_i32 s57, 8192
  buffer_load_dwordx4 v3, s[28:31], s57 offen lds
  s_waitcnt vmcnt(26)
  s_barrier
  s_waitcnt vmcnt(18)
  v_cmp_eq_u32 vcc, 1, v37
  s_cmp_eq_u64 vcc, -1
  s_cbranch_scc0 Lslow_34
Ldone_35:
  s_waitcnt vmcnt(17)
  v_cmp_eq_u32 vcc, 1, v39
  s_cmp_eq_u64 vcc, -1
  s_cbranch_scc0 Lslow_37
Ldone_38:
  s_lshl_b32 s58, s83, 13
  s_lshl_b32 s59, s47, 12
  s_add_u32 s58, s58, s59
  s_add_u32 s57, s58, 12582912
  s_mul_i32 s59, s47, 3072
  s_add_u32 m0, s59, 149504
  s_nop 0
  buffer_load_dwordx4 v2, s[36:39], s57 offen offset:0 sc1 lds
  buffer_load_dwordx4 v2, s[36:39], s57 offen offset:1024 sc1 lds
  buffer_load_dwordx4 v2, s[36:39], s57 offen offset:2048 sc1 lds
  s_add_u32 m0, s49, 114688
  s_add_u32 s57, s55, 6295552
  buffer_load_dwordx4 v2, s[36:39], s57 offen offset:0 sc1 lds
  buffer_load_dwordx4 v2, s[36:39], s57 offen offset:1024 sc1 lds
  buffer_load_dwordx4 v2, s[36:39], s57 offen offset:2048 sc1 lds
  buffer_load_dwordx4 v2, s[36:39], s57 offen offset:3072 sc1 lds
  s_add_u32 m0, s49, 118784
  s_add_u32 s57, s55, 6307840
  buffer_load_dwordx4 v2, s[36:39], s57 offen offset:0 sc1 lds
  buffer_load_dwordx4 v2, s[36:39], s57 offen offset:1024 sc1 lds
  buffer_load_dwordx4 v2, s[36:39], s57 offen offset:2048 sc1 lds
  buffer_load_dwordx4 v2, s[36:39], s57 offen offset:3072 sc1 lds
  s_add_u32 m0, s49, 131072
  s_add_u32 s57, s55, 6320128
  buffer_load_dwordx4 v2, s[36:39], s57 offen offset:0 sc1 lds
  buffer_load_dwordx4 v2, s[36:39], s57 offen offset:1024 sc1 lds
  buffer_load_dwordx4 v2, s[36:39], s57 offen offset:2048 sc1 lds
  buffer_load_dwordx4 v2, s[36:39], s57 offen offset:3072 sc1 lds
  s_add_u32 m0, s49, 135168
  s_add_u32 s57, s55, 6332416
  buffer_load_dwordx4 v2, s[36:39], s57 offen offset:0 sc1 lds
  buffer_load_dwordx4 v2, s[36:39], s57 offen offset:1024 sc1 lds
  buffer_load_dwordx4 v2, s[36:39], s57 offen offset:2048 sc1 lds
  buffer_load_dwordx4 v2, s[36:39], s57 offen offset:3072 sc1 lds
  s_waitcnt vmcnt(35)
  s_barrier
  s_add_u32 m0, s49, 81920
  s_add_u32 s57, s53, 851968
  buffer_load_dwordx4 v3, s[28:31], s57 offen lds
  s_addk_i32 m0, 1024
  s_addk_i32 s57, 8192
  buffer_load_dwordx4 v3, s[28:31], s57 offen lds
  s_addk_i32 m0, 1024
  s_addk_i32 s57, 8192
  buffer_load_dwordx4 v3, s[28:31], s57 offen lds
  s_addk_i32 m0, 1024
  s_addk_i32 s57, 8192
  buffer_load_dwordx4 v3, s[28:31], s57 offen lds
  s_addk_i32 m0, 1024
  s_addk_i32 s57, 8192
  buffer_load_dwordx4 v3, s[28:31], s57 offen lds
  s_addk_i32 m0, 1024
  s_addk_i32 s57, 8192
  buffer_load_dwordx4 v3, s[28:31], s57 offen lds
  s_addk_i32 m0, 1024
  s_addk_i32 s57, 8192
  buffer_load_dwordx4 v3, s[28:31], s57 offen lds
  s_addk_i32 m0, 1024
  s_addk_i32 s57, 8192
  buffer_load_dwordx4 v3, s[28:31], s57 offen lds
  s_add_u32 m0, s49, 0
  s_add_u32 s57, s55, 6344704
  buffer_load_dwordx4 v2, s[36:39], s57 offen offset:0 sc1 lds
  buffer_load_dwordx4 v2, s[36:39], s57 offen offset:1024 sc1 lds
  buffer_load_dwordx4 v2, s[36:39], s57 offen offset:2048 sc1 lds
  buffer_load_dwordx4 v2, s[36:39], s57 offen offset:3072 sc1 lds
  s_add_u32 m0, s49, 4096
  s_add_u32 s57, s55, 6356992
  buffer_load_dwordx4 v2, s[36:39], s57 offen offset:0 sc1 lds
  buffer_load_dwordx4 v2, s[36:39], s57 offen offset:1024 sc1 lds
  buffer_load_dwordx4 v2, s[36:39], s57 offen offset:2048 sc1 lds
  buffer_load_dwordx4 v2, s[36:39], s57 offen offset:3072 sc1 lds
  s_waitcnt vmcnt(32)
  s_barrier
  s_add_u32 m0, s49, 98304
  s_add_u32 s57, s53, 1245184
  buffer_load_dwordx4 v3, s[28:31], s57 offen lds
  s_addk_i32 m0, 1024
  s_addk_i32 s57, 8192
  buffer_load_dwordx4 v3, s[28:31], s57 offen lds
  s_addk_i32 m0, 1024
  s_addk_i32 s57, 8192
  buffer_load_dwordx4 v3, s[28:31], s57 offen lds
  s_addk_i32 m0, 1024
  s_addk_i32 s57, 8192
  buffer_load_dwordx4 v3, s[28:31], s57 offen lds
  s_addk_i32 m0, 1024
  s_addk_i32 s57, 8192
  buffer_load_dwordx4 v3, s[28:31], s57 offen lds
  s_addk_i32 m0, 1024
  s_addk_i32 s57, 8192
  buffer_load_dwordx4 v3, s[28:31], s57 offen lds
  s_addk_i32 m0, 1024
  s_addk_i32 s57, 8192
  buffer_load_dwordx4 v3, s[28:31], s57 offen lds
  s_addk_i32 m0, 1024
  s_addk_i32 s57, 8192
  buffer_load_dwordx4 v3, s[28:31], s57 offen lds
  s_add_u32 m0, s49, 16384
  s_add_u32 s57, s55, 6369280
  buffer_load_dwordx4 v2, s[36:39], s57 offen offset:0 sc1 lds
  buffer_load_dwordx4 v2, s[36:39], s57 offen offset:1024 sc1 lds
  buffer_load_dwordx4 v2, s[36:39], s57 offen offset:2048 sc1 lds
  buffer_load_dwordx4 v2, s[36:39], s57 offen offset:3072 sc1 lds
  s_add_u32 m0, s49, 20480
  s_add_u32 s57, s55, 6381568
  buffer_load_dwordx4 v2, s[36:39], s57 offen offset:0 sc1 lds
  buffer_load_dwordx4 v2, s[36:39], s57 offen offset:1024 sc1 lds
  buffer_load_dwordx4 v2, s[36:39], s57 offen offset:2048 sc1 lds
  buffer_load_dwordx4 v2, s[36:39], s57 offen offset:3072 sc1 lds
  s_add_u32 m0, s49, 32768
  s_add_u32 s57, s53, 131072
  buffer_load_dwordx4 v3, s[28:31], s57 offen lds
  s_waitcnt vmcnt(41)
  s_barrier
  s_mov_b32 s76, 12734464
  buffer_load_dword v38, v10, s[36:39], s76 offen sc1
  s_addk_i32 m0, 1024
  s_addk_i32 s57, 8192
  buffer_load_dwordx4 v3, s[28:31], s57 offen lds
  s_addk_i32 m0, 1024
  s_addk_i32 s57, 8192
  buffer_load_dwordx4 v3, s[28:31], s57 offen lds
  s_addk_i32 m0, 1024
  s_addk_i32 s57, 8192
  buffer_load_dwordx4 v3, s[28:31], s57 offen lds
  s_addk_i32 m0, 1024
  s_addk_i32 s57, 8192
  buffer_load_dwordx4 v3, s[28:31], s57 offen lds
  s_addk_i32 m0, 1024
  s_addk_i32 s57, 8192
  buffer_load_dwordx4 v3, s[28:31], s57 offen lds
  s_addk_i32 m0, 1024
  s_addk_i32 s57, 8192
  buffer_load_dwordx4 v3, s[28:31], s57 offen lds
  s_addk_i32 m0, 1024
  s_addk_i32 s57, 8192
  buffer_load_dwordx4 v3, s[28:31], s57 offen lds
  s_waitcnt vmcnt(41)
  s_barrier
  s_add_u32 m0, s49, 114688
  s_add_u32 s57, s53, 524288
  buffer_load_dwordx4 v3, s[28:31], s57 offen lds
  s_addk_i32 m0, 1024
  s_addk_i32 s57, 8192
  buffer_load_dwordx4 v3, s[28:31], s57 offen lds
  s_addk_i32 m0, 1024
  s_addk_i32 s57, 8192
  buffer_load_dwordx4 v3, s[28:31], s57 offen lds
  s_addk_i32 m0, 1024
  s_addk_i32 s57, 8192
  buffer_load_dwordx4 v3, s[28:31], s57 offen lds
  s_addk_i32 m0, 1024
  s_addk_i32 s57, 8192
  buffer_load_dwordx4 v3, s[28:31], s57 offen lds
  s_addk_i32 m0, 1024
  s_addk_i32 s57, 8192
  buffer_load_dwordx4 v3, s[28:31], s57 offen lds
  s_addk_i32 m0, 1024
  s_addk_i32 s57, 8192
  buffer_load_dwordx4 v3, s[28:31], s57 offen lds
  s_addk_i32 m0, 1024
  s_addk_i32 s57, 8192
  buffer_load_dwordx4 v3, s[28:31], s57 offen lds
  s_waitcnt vmcnt(33)
  s_barrier
  s_waitcnt vmcnt(15)
  v_cmp_eq_u32 vcc, 1, v38
  s_cmp_eq_u64 vcc, -1
  s_cbranch_scc0 Lslow_40
Ldone_41:
  s_add_u32 m0, s49, 49152
  s_add_u32 s57, s55, 6299648
  buffer_load_dwordx4 v2, s[36:39], s57 offen offset:0 sc1 lds
  buffer_load_dwordx4 v2, s[36:39], s57 offen offset:1024 sc1 lds
  buffer_load_dwordx4 v2, s[36:39], s57 offen offset:2048 sc1 lds
  buffer_load_dwordx4 v2, s[36:39], s57 offen offset:3072 sc1 lds
  s_add_u32 m0, s49, 53248
  s_add_u32 s57, s55, 6311936
  buffer_load_dwordx4 v2, s[36:39], s57 offen offset:0 sc1 lds
  buffer_load_dwordx4 v2, s[36:39], s57 offen offset:1024 sc1 lds
  buffer_load_dwordx4 v2, s[36:39], s57 offen offset:2048 sc1 lds
  buffer_load_dwordx4 v2, s[36:39], s57 offen offset:3072 sc1 lds
  s_add_u32 m0, s49, 65536
  s_add_u32 s57, s55, 6324224
  buffer_load_dwordx4 v2, s[36:39], s57 offen offset:0 sc1 lds
  buffer_load_dwordx4 v2, s[36:39], s57 offen offset:1024 sc1 lds
  buffer_load_dwordx4 v2, s[36:39], s57 offen offset:2048 sc1 lds
  buffer_load_dwordx4 v2, s[36:39], s57 offen offset:3072 sc1 lds
  s_add_u32 m0, s49, 69632
  s_add_u32 s57, s55, 6336512
  buffer_load_dwordx4 v2, s[36:39], s57 offen offset:0 sc1 lds
  buffer_load_dwordx4 v2, s[36:39], s57 offen offset:1024 sc1 lds
  buffer_load_dwordx4 v2, s[36:39], s57 offen offset:2048 sc1 lds
  buffer_load_dwordx4 v2, s[36:39], s57 offen offset:3072 sc1 lds
  s_barrier
  s_add_u32 m0, s49, 131072
  s_add_u32 s57, s53, 917504
  buffer_load_dwordx4 v3, s[28:31], s57 offen lds
  s_addk_i32 m0, 1024
  s_addk_i32 s57, 8192
  buffer_load_dwordx4 v3, s[28:31], s57 offen lds
  s_addk_i32 m0, 1024
  s_addk_i32 s57, 8192
  buffer_load_dwordx4 v3, s[28:31], s57 offen lds
  s_addk_i32 m0, 1024
  s_addk_i32 s57, 8192
  buffer_load_dwordx4 v3, s[28:31], s57 offen lds
  s_addk_i32 m0, 1024
  s_addk_i32 s57, 8192
  buffer_load_dwordx4 v3, s[28:31], s57 offen lds
  s_addk_i32 m0, 1024
  s_addk_i32 s57, 8192
  buffer_load_dwordx4 v3, s[28:31], s57 offen lds
  s_addk_i32 m0, 1024
  s_addk_i32 s57, 8192
  buffer_load_dwordx4 v3, s[28:31], s57 offen lds
  s_addk_i32 m0, 1024
  s_addk_i32 s57, 8192
  buffer_load_dwordx4 v3, s[28:31], s57 offen lds
  s_add_u32 m0, s49, 81920
  s_add_u32 s57, s55, 6348800
  buffer_load_dwordx4 v2, s[36:39], s57 offen offset:0 sc1 lds
  buffer_load_dwordx4 v2, s[36:39], s57 offen offset:1024 sc1 lds
  buffer_load_dwordx4 v2, s[36:39], s57 offen offset:2048 sc1 lds
  buffer_load_dwordx4 v2, s[36:39], s57 offen offset:3072 sc1 lds
  s_add_u32 m0, s49, 86016
  s_add_u32 s57, s55, 6361088
  buffer_load_dwordx4 v2, s[36:39], s57 offen offset:0 sc1 lds
  buffer_load_dwordx4 v2, s[36:39], s57 offen offset:1024 sc1 lds
  buffer_load_dwordx4 v2, s[36:39], s57 offen offset:2048 sc1 lds
  buffer_load_dwordx4 v2, s[36:39], s57 offen offset:3072 sc1 lds
  s_waitcnt vmcnt(24)
  s_barrier
  s_mov_b32 s76, 12722176
  buffer_load_dword v35, v10, s[36:39], s76 offen sc1
  s_add_u32 m0, s49, 0
  s_add_u32 s57, s53, 1310720
  buffer_load_dwordx4 v3, s[28:31], s57 offen lds
  s_addk_i32 m0, 1024
  s_addk_i32 s57, 8192
  buffer_load_dwordx4 v3, s[28:31], s57 offen lds
  s_addk_i32 m0, 1024
  s_addk_i32 s57, 8192
  buffer_load_dwordx4 v3, s[28:31], s57 offen lds
  s_addk_i32 m0, 1024
  s_addk_i32 s57, 8192
  buffer_load_dwordx4 v3, s[28:31], s57 offen lds
  s_addk_i32 m0, 1024
  s_addk_i32 s57, 8192
  buffer_load_dwordx4 v3, s[28:31], s57 offen lds
  s_addk_i32 m0, 1024
  s_addk_i32 s57, 8192
  buffer_load_dwordx4 v3, s[28:31], s57 offen lds
  s_addk_i32 m0, 1024
  s_addk_i32 s57, 8192
  buffer_load_dwordx4 v3, s[28:31], s57 offen lds
  s_addk_i32 m0, 1024
  s_addk_i32 s57, 8192
  buffer_load_dwordx4 v3, s[28:31], s57 offen lds
  s_add_u32 m0, s49, 98304
  s_add_u32 s57, s55, 6373376
  buffer_load_dwordx4 v2, s[36:39], s57 offen offset:0 sc1 lds
  buffer_load_dwordx4 v2, s[36:39], s57 offen offset:1024 sc1 lds
  buffer_load_dwordx4 v2, s[36:39], s57 offen offset:2048 sc1 lds
  buffer_load_dwordx4 v2, s[36:39], s57 offen offset:3072 sc1 lds
  s_add_u32 m0, s49, 102400
  s_add_u32 s57, s55, 6385664
  buffer_load_dwordx4 v2, s[36:39], s57 offen offset:0 sc1 lds
  buffer_load_dwordx4 v2, s[36:39], s57 offen offset:1024 sc1 lds
  buffer_load_dwordx4 v2, s[36:39], s57 offen offset:2048 sc1 lds
  buffer_load_dwordx4 v2, s[36:39], s57 offen offset:3072 sc1 lds
  s_waitcnt vmcnt(33)
  s_barrier
  s_add_u32 m0, s49, 16384
  s_add_u32 s57, s50, 0
  buffer_load_dwordx4 v3, s[12:15], s57 offen lds
  s_addk_i32 m0, 1024
  s_addk_i32 s57, 8192
  buffer_load_dwordx4 v3, s[12:15], s57 offen lds
  s_addk_i32 m0, 1024
  s_addk_i32 s57, 8192
  buffer_load_dwordx4 v3, s[12:15], s57 offen lds
  s_addk_i32 m0, 1024
  s_addk_i32 s57, 8192
  buffer_load_dwordx4 v3, s[12:15], s57 offen lds
  s_addk_i32 m0, 1024
  s_addk_i32 s57, 8192
  buffer_load_dwordx4 v3, s[12:15], s57 offen lds
  s_addk_i32 m0, 1024
  s_addk_i32 s57, 8192
  buffer_load_dwordx4 v3, s[12:15], s57 offen lds
  s_addk_i32 m0, 1024
  s_addk_i32 s57, 8192
  buffer_load_dwordx4 v3, s[12:15], s57 offen lds
  s_addk_i32 m0, 1024
  s_addk_i32 s57, 8192
  buffer_load_dwordx4 v3, s[12:15], s57 offen lds
  s_add_u32 m0, s49, 49152
  s_add_u32 s57, s50, 131072
  buffer_load_dwordx4 v3, s[12:15], s57 offen lds
  s_addk_i32 m0, 1024
  s_addk_i32 s57, 8192
  buffer_load_dwordx4 v3, s[12:15], s57 offen lds
  s_addk_i32 m0, 1024
  s_addk_i32 s57, 8192
  buffer_load_dwordx4 v3, s[12:15], s57 offen lds
  s_addk_i32 m0, 1024
  s_addk_i32 s57, 8192
  buffer_load_dwordx4 v3, s[12:15], s57 offen lds
  s_addk_i32 m0, 1024
  s_addk_i32 s57, 8192
  buffer_load_dwordx4 v3, s[12:15], s57 offen lds
  s_addk_i32 m0, 1024
  s_addk_i32 s57, 8192
  buffer_load_dwordx4 v3, s[12:15], s57 offen lds
  s_addk_i32 m0, 1024
  s_addk_i32 s57, 8192
  buffer_load_dwordx4 v3, s[12:15], s57 offen lds
  s_addk_i32 m0, 1024
  s_addk_i32 s57, 8192
  buffer_load_dwordx4 v3, s[12:15], s57 offen lds
  s_waitcnt vmcnt(33)
  s_barrier
  s_waitcnt vmcnt(32)
  v_cmp_eq_u32 vcc, 1, v35
  s_cmp_eq_u64 vcc, -1
  s_cbranch_scc0 Lslow_43
Ldone_44:
  s_add_u32 m0, s49, 32768
  s_add_u32 s57, s54, 4194304
  buffer_load_dwordx4 v2, s[36:39], s57 offen offset:0 sc1 lds
  buffer_load_dwordx4 v2, s[36:39], s57 offen offset:1024 sc1 lds
  buffer_load_dwordx4 v2, s[36:39], s57 offen offset:2048 sc1 lds
  buffer_load_dwordx4 v2, s[36:39], s57 offen offset:3072 sc1 lds
  s_add_u32 m0, s49, 36864
  s_add_u32 s57, s54, 4198400
  buffer_load_dwordx4 v2, s[36:39], s57 offen offset:0 sc1 lds
  buffer_load_dwordx4 v2, s[36:39], s57 offen offset:1024 sc1 lds
  buffer_load_dwordx4 v2, s[36:39], s57 offen offset:2048 sc1 lds
  buffer_load_dwordx4 v2, s[36:39], s57 offen offset:3072 sc1 lds
  s_add_u32 m0, s49, 114688
  s_add_u32 s57, s54, 4202496
  buffer_load_dwordx4 v2, s[36:39], s57 offen offset:0 sc1 lds
  buffer_load_dwordx4 v2, s[36:39], s57 offen offset:1024 sc1 lds
  buffer_load_dwordx4 v2, s[36:39], s57 offen offset:2048 sc1 lds
  buffer_load_dwordx4 v2, s[36:39], s57 offen offset:3072 sc1 lds
  s_add_u32 m0, s49, 118784
  s_add_u32 s57, s54, 4206592
  buffer_load_dwordx4 v2, s[36:39], s57 offen offset:0 sc1 lds
  buffer_load_dwordx4 v2, s[36:39], s57 offen offset:1024 sc1 lds
  buffer_load_dwordx4 v2, s[36:39], s57 offen offset:2048 sc1 lds
  buffer_load_dwordx4 v2, s[36:39], s57 offen offset:3072 sc1 lds
  s_waitcnt vmcnt(32)
  s_barrier
  s_add_u32 m0, s49, 65536
  s_add_u32 s57, s50, 262144
  buffer_load_dwordx4 v3, s[12:15], s57 offen lds
  s_addk_i32 m0, 1024
  s_addk_i32 s57, 8192
  buffer_load_dwordx4 v3, s[12:15], s57 offen lds
  s_addk_i32 m0, 1024
  s_addk_i32 s57, 8192
  buffer_load_dwordx4 v3, s[12:15], s57 offen lds
  s_addk_i32 m0, 1024
  s_addk_i32 s57, 8192
  buffer_load_dwordx4 v3, s[12:15], s57 offen lds
  s_addk_i32 m0, 1024
  s_addk_i32 s57, 8192
  buffer_load_dwordx4 v3, s[12:15], s57 offen lds
  s_addk_i32 m0, 1024
  s_addk_i32 s57, 8192
  buffer_load_dwordx4 v3, s[12:15], s57 offen lds
  s_addk_i32 m0, 1024
  s_addk_i32 s57, 8192
  buffer_load_dwordx4 v3, s[12:15], s57 offen lds
  s_addk_i32 m0, 1024
  s_addk_i32 s57, 8192
  buffer_load_dwordx4 v3, s[12:15], s57 offen lds
  s_add_u32 m0, s49, 131072
  s_add_u32 s57, s54, 4210688
  buffer_load_dwordx4 v2, s[36:39], s57 offen offset:0 sc1 lds
  buffer_load_dwordx4 v2, s[36:39], s57 offen offset:1024 sc1 lds
  buffer_load_dwordx4 v2, s[36:39], s57 offen offset:2048 sc1 lds
  buffer_load_dwordx4 v2, s[36:39], s57 offen offset:3072 sc1 lds
  s_add_u32 m0, s49, 135168
  s_add_u32 s57, s54, 4214784
  buffer_load_dwordx4 v2, s[36:39], s57 offen offset:0 sc1 lds
  buffer_load_dwordx4 v2, s[36:39], s57 offen offset:1024 sc1 lds
  buffer_load_dwordx4 v2, s[36:39], s57 offen offset:2048 sc1 lds
  buffer_load_dwordx4 v2, s[36:39], s57 offen offset:3072 sc1 lds
  s_waitcnt vmcnt(24)
  s_barrier
  s_add_u32 m0, s49, 81920
  s_add_u32 s57, s50, 393216
  buffer_load_dwordx4 v3, s[12:15], s57 offen lds
  s_addk_i32 m0, 1024
  s_addk_i32 s57, 8192
  buffer_load_dwordx4 v3, s[12:15], s57 offen lds
  s_addk_i32 m0, 1024
  s_addk_i32 s57, 8192
  buffer_load_dwordx4 v3, s[12:15], s57 offen lds
  s_addk_i32 m0, 1024
  s_addk_i32 s57, 8192
  buffer_load_dwordx4 v3, s[12:15], s57 offen lds
  s_addk_i32 m0, 1024
  s_addk_i32 s57, 8192
  buffer_load_dwordx4 v3, s[12:15], s57 offen lds
  s_addk_i32 m0, 1024
  s_addk_i32 s57, 8192
  buffer_load_dwordx4 v3, s[12:15], s57 offen lds
  s_addk_i32 m0, 1024
  s_addk_i32 s57, 8192
  buffer_load_dwordx4 v3, s[12:15], s57 offen lds
  s_addk_i32 m0, 1024
  s_addk_i32 s57, 8192
  buffer_load_dwordx4 v3, s[12:15], s57 offen lds
  s_add_u32 m0, s49, 0
  s_add_u32 s57, s54, 4218880
  buffer_load_dwordx4 v2, s[36:39], s57 offen offset:0 sc1 lds
  buffer_load_dwordx4 v2, s[36:39], s57 offen offset:1024 sc1 lds
  buffer_load_dwordx4 v2, s[36:39], s57 offen offset:2048 sc1 lds
  buffer_load_dwordx4 v2, s[36:39], s57 offen offset:3072 sc1 lds
  s_add_u32 m0, s49, 4096
  s_add_u32 s57, s54, 4222976
  buffer_load_dwordx4 v2, s[36:39], s57 offen offset:0 sc1 lds
  buffer_load_dwordx4 v2, s[36:39], s57 offen offset:1024 sc1 lds
  buffer_load_dwordx4 v2, s[36:39], s57 offen offset:2048 sc1 lds
  buffer_load_dwordx4 v2, s[36:39], s57 offen offset:3072 sc1 lds
  s_waitcnt vmcnt(32)
  s_barrier
  s_waitcnt vmcnt(16)
  s_barrier
  s_waitcnt vmcnt(0)
  s_barrier
  s_endpgm
Lslow_1:
  s_mov_b32 s74, 8000
Lspin_3:
  buffer_load_dword v32, v12, s[40:43], 0 offen sc1
  s_waitcnt vmcnt(0)
  v_cmp_le_u32 vcc, v13, v32
  s_cmp_eq_u64 vcc, -1
  s_cbranch_scc1 Ldone_2
  s_sleep 2
  s_sub_u32 s74, s74, 1
  s_cmp_lg_u32 s74, 0
  s_cbranch_scc1 Lspin_3
  s_branch Ldone_2
Lslow_4:
  s_mov_b32 s74, 8000
  s_mov_b32 s76, 12713984
Lspin_6:
  buffer_load_dword v33, v9, s[36:39], s76 offen sc1
  s_waitcnt vmcnt(0)
  v_cmp_eq_u32 vcc, 1, v33
  s_mov_b32 s72, 0xc0c
  s_mov_b32 s73, 0x0
  s_and_b64 vcc, vcc, s[72:73]
  s_cmp_eq_u64 vcc, s[72:73]
  s_cbranch_scc1 Ldone_5
  s_sleep 2
  s_sub_u32 s74, s74, 1
  s_cmp_lg_u32 s74, 0
  s_cbranch_scc1 Lspin_6
  s_branch Ldone_5
Lslow_7:
  s_mov_b32 s74, 8000
  s_mov_b32 s76, 12713984
Lspin_9:
  buffer_load_dword v33, v9, s[36:39], s76 offen sc1
  s_waitcnt vmcnt(0)
  v_cmp_eq_u32 vcc, 1, v33
  s_mov_b32 s72, 0xc0c0
  s_mov_b32 s73, 0x0
  s_and_b64 vcc, vcc, s[72:73]
  s_cmp_eq_u64 vcc, s[72:73]
  s_cbranch_scc1 Ldone_8
  s_sleep 2
  s_sub_u32 s74, s74, 1
  s_cmp_lg_u32 s74, 0
  s_cbranch_scc1 Lspin_9
  s_branch Ldone_8
Lslow_10:
  s_mov_b32 s74, 8000
  s_mov_b32 s76, 12713984
Lspin_12:
  buffer_load_dword v33, v9, s[36:39], s76 offen sc1
  s_waitcnt vmcnt(0)
  v_cmp_eq_u32 vcc, 1, v33
  s_mov_b32 s72, 0x303000
  s_mov_b32 s73, 0x0
  s_and_b64 vcc, vcc, s[72:73]
  s_cmp_eq_u64 vcc, s[72:73]
  s_cbranch_scc1 Ldone_11
  s_sleep 2
  s_sub_u32 s74, s74, 1
  s_cmp_lg_u32 s74, 0
  s_cbranch_scc1 Lspin_12
  s_branch Ldone_11
Lslow_13:
  s_mov_b32 s74, 8000
  s_mov_b32 s76, 12713984
Lspin_15:
  buffer_load_dword v33, v9, s[36:39], s76 offen sc1
  s_waitcnt vmcnt(0)
  v_cmp_eq_u32 vcc, 1, v33
  s_mov_b32 s72, 0x30300
  s_mov_b32 s73, 0x0
  s_and_b64 vcc, vcc, s[72:73]
  s_cmp_eq_u64 vcc, s[72:73]
  s_cbranch_scc1 Ldone_14
  s_sleep 2
  s_sub_u32 s74, s74, 1
  s_cmp_lg_u32 s74, 0
  s_cbranch_scc1 Lspin_15
  s_branch Ldone_14
Lslow_16:
  s_mov_b32 s74, 8000
  s_mov_b32 s76, 12742656
Lspin_18:
  buffer_load_dword v40, v8, s[36:39], s76 offen sc1
  s_waitcnt vmcnt(0)
  v_cmp_ne_u32 vcc, 0, v40
  s_cmp_eq_u64 vcc, -1
  s_cbranch_scc1 Ldone_17
  s_sleep 2
  s_sub_u32 s74, s74, 1
  s_cmp_lg_u32 s74, 0
  s_cbranch_scc1 Lspin_18
  s_branch Ldone_17
Lslow_19:
  s_mov_b32 s74, 8000
  s_mov_b32 s76, 12718080
Lspin_21:
  buffer_load_dword v34, v10, s[36:39], s76 offen sc1
  s_waitcnt vmcnt(0)
  v_cmp_eq_u32 vcc, 1, v34
  s_mov_b32 s72, 0x3
  s_mov_b32 s73, 0x0
  s_and_b64 vcc, vcc, s[72:73]
  s_cmp_eq_u64 vcc, s[72:73]
  s_cbranch_scc1 Ldone_20
  s_sleep 2
  s_sub_u32 s74, s74, 1
  s_cmp_lg_u32 s74, 0
  s_cbranch_scc1 Lspin_21
  s_branch Ldone_20
Lslow_22:
  s_mov_b32 s74, 8000
  s_mov_b32 s76, 12718080
Lspin_24:
  buffer_load_dword v34, v10, s[36:39], s76 offen sc1
  s_waitcnt vmcnt(0)
  v_cmp_eq_u32 vcc, 1, v34
  s_mov_b32 s72, 0x30
  s_mov_b32 s73, 0x0
  s_and_b64 vcc, vcc, s[72:73]
  s_cmp_eq_u64 vcc, s[72:73]
  s_cbranch_scc1 Ldone_23
  s_sleep 2
  s_sub_u32 s74, s74, 1
  s_cmp_lg_u32 s74, 0
  s_cbranch_scc1 Lspin_24
  s_branch Ldone_23
Lslow_25:
  s_mov_b32 s74, 8000
  s_mov_b32 s76, 12718080
Lspin_27:
  buffer_load_dword v34, v10, s[36:39], s76 offen sc1
  s_waitcnt vmcnt(0)
  v_cmp_eq_u32 vcc, 1, v34
  s_mov_b32 s72, 0xc0
  s_mov_b32 s73, 0x0
  s_and_b64 vcc, vcc, s[72:73]
  s_cmp_eq_u64 vcc, s[72:73]
  s_cbranch_scc1 Ldone_26
  s_sleep 2
  s_sub_u32 s74, s74, 1
  s_cmp_lg_u32 s74, 0
  s_cbranch_scc1 Lspin_27
  s_branch Ldone_26
Lslow_28:
  s_mov_b32 s74, 8000
  s_mov_b32 s76, 12718080
Lspin_30:
  buffer_load_dword v34, v10, s[36:39], s76 offen sc1
  s_waitcnt vmcnt(0)
  v_cmp_eq_u32 vcc, 1, v34
  s_mov_b32 s72, 0xc
  s_mov_b32 s73, 0x0
  s_and_b64 vcc, vcc, s[72:73]
  s_cmp_eq_u64 vcc, s[72:73]
  s_cbranch_scc1 Ldone_29
  s_sleep 2
  s_sub_u32 s74, s74, 1
  s_cmp_lg_u32 s74, 0
  s_cbranch_scc1 Lspin_30
  s_branch Ldone_29
Lslow_31:
  s_mov_b32 s74, 8000
  s_mov_b32 s76, 12726272
Lspin_33:
  buffer_load_dword v36, v10, s[36:39], s76 offen sc1
  s_waitcnt vmcnt(0)
  v_cmp_eq_u32 vcc, 1, v36
  s_cmp_eq_u64 vcc, -1
  s_cbranch_scc1 Ldone_32
  s_sleep 2
  s_sub_u32 s74, s74, 1
  s_cmp_lg_u32 s74, 0
  s_cbranch_scc1 Lspin_33
  s_branch Ldone_32
Lslow_34:
  s_mov_b32 s74, 8000
  s_mov_b32 s76, 12730368
Lspin_36:
  buffer_load_dword v37, v10, s[36:39], s76 offen sc1
  s_waitcnt vmcnt(0)
  v_cmp_eq_u32 vcc, 1, v37
  s_cmp_eq_u64 vcc, -1
  s_cbranch_scc1 Ldone_35
  s_sleep 2
  s_sub_u32 s74, s74, 1
  s_cmp_lg_u32 s74, 0
  s_cbranch_scc1 Lspin_36
  s_branch Ldone_35
Lslow_37:
  s_mov_b32 s74, 8000
  s_mov_b32 s76, 12738560
Lspin_39:
  buffer_load_dword v39, v11, s[36:39], s76 offen sc1
  s_waitcnt vmcnt(0)
  v_cmp_eq_u32 vcc, 1, v39
  s_cmp_eq_u64 vcc, -1
  s_cbranch_scc1 Ldone_38
  s_sleep 2
  s_sub_u32 s74, s74, 1
  s_cmp_lg_u32 s74, 0
  s_cbranch_scc1 Lspin_39
  s_branch Ldone_38
Lslow_40:
  s_mov_b32 s74, 8000
  s_mov_b32 s76, 12734464
Lspin_42:
  buffer_load_dword v38, v10, s[36:39], s76 offen sc1
  s_waitcnt vmcnt(0)
  v_cmp_eq_u32 vcc, 1, v38
  s_cmp_eq_u64 vcc, -1
  s_cbranch_scc1 Ldone_41
  s_sleep 2
  s_sub_u32 s74, s74, 1
  s_cmp_lg_u32 s74, 0
  s_cbranch_scc1 Lspin_42
  s_branch Ldone_41
Lslow_43:
  s_mov_b32 s74, 8000
  s_mov_b32 s76, 12722176
Lspin_45:
  buffer_load_dword v35, v10, s[36:39], s76 offen sc1
  s_waitcnt vmcnt(0)
  v_cmp_eq_u32 vcc, 1, v35
  s_cmp_eq_u64 vcc, -1
  s_cbranch_scc1 Ldone_44
  s_sleep 2
  s_sub_u32 s74, s74, 1
  s_cmp_lg_u32 s74, 0
  s_cbranch_scc1 Lspin_45
  s_branch Ldone_44
.p2align 6
Lcompute:
  s_and_b32 s47, s46, 1
  s_lshr_b32 s48, s46, 1
  s_lshl_b32 s60, s44, 1
  s_add_u32 s60, s60, s47
  v_and_b32 v56, 15, v1
  v_lshrrev_b32 v57, 2, v56
  v_and_b32 v58, 3, v1
  v_bfe_u32 v59, v1, 4, 1
  v_lshrrev_b32 v60, 5, v1
  v_lshrrev_b32 v61, 1, v58
  v_lshl_add_u32 v61, v59, 1, v61
  s_lshl_b32 s58, s48, 2
  v_add_u32 v61, s58, v61
  v_lshrrev_b32 v62, 1, v57
  v_lshlrev_b32 v62, 2, v62
  v_xor_b32 v61, v61, v62
  v_and_b32 v62, 1, v58
  v_lshlrev_b32 v62, 3, v62
  v_lshl_add_u32 v61, v61, 4, v62
  v_lshl_add_u32 v62, v60, 3, v57
  v_lshl_add_u32 v3, v62, 7, v61
  v_lshl_add_u32 v62, v60, 2, v57
  v_lshl_add_u32 v6, v62, 7, v61
  v_add_u32 v4, 0x10000, v3
  v_add_u32 v5, 0x20000, v3
  v_add_u32 v7, 0x10000, v6
  v_add_u32 v8, 0x20000, v6
  s_lshl_b32 s58, s47, 13
  v_add_u32 v9, s58, v2
  v_add_u32 v10, 0x10000, v9
  v_add_u32 v11, 0x20000, v9
  v_and_b32 v63, 31, v1
  s_lshl_b32 s58, s47, 5
  v_add_u32 v62, s58, v63
  v_mul_u32_u24 v12, 1040, v62
  v_lshl_add_u32 v12, v60, 4, v12
  v_add_u32 v12, 81920, v12
  s_lshl_b32 s58, s60, 15
  s_lshl_b32 s59, s45, 7
  s_add_u32 s58, s58, s59
  s_lshl_b32 s59, s48, 6
  s_add_u32 s58, s58, s59
  v_lshl_add_u32 v15, v63, 10, s58
  v_lshl_add_u32 v15, v60, 4, v15
  v_lshlrev_b32 v16, 3, v63
  v_mov_b32 v62, 0x80000000
  v_cmp_gt_u32 vcc, 32, v1
  v_mov_b32 v64, 0
  s_nop 0
  v_cndmask_b32 v16, v62, v16, vcc
  v_cmp_eq_u32 vcc, 0, v0
  v_lshrrev_b32 v28, 4, v1
  v_and_b32 v28, 1, v28
  v_cndmask_b32 v14, v62, v64, vcc
  v_and_b32 v64, 3, v1
  v_cmp_eq_u32 vcc, v64, v28
  v_mov_b32 v62, 0
  v_mov_b32 v64, 0x3f803f80
  v_cndmask_b32 v28, v62, v64, vcc
  v_cndmask_b32 v29, v62, v64, vcc
  v_cndmask_b32 v30, v62, v64, vcc
  v_cndmask_b32 v31, v62, v64, vcc
  s_and_b32 s58, s44, 7
  s_cmp_eq_u32 s58, s45
  s_cselect_b32 s58, 0, 1
  s_min_u32 s59, s46, 1
  s_or_b32 s58, s58, s59
  s_lshl_b32 s56, s58, 31
  v_lshrrev_b32 v100, 3, v1
  v_lshlrev_b32 v101, 12, v100
  v_and_b32 v102, 7, v1
  v_lshl_add_u32 v101, v102, 4, v101
  s_lshl_b32 s58, s44, 7
  s_lshr_b32 s59, s44, 2
  s_lshl_b32 s59, s59, 7
  v_mov_b32 v102, s58
  v_mov_b32 v103, s59
  v_cmp_le_u32 vcc, 6, v100
  v_mov_b32 v104, 0
  v_mov_b32 v105, 0
  v_cndmask_b32 v102, v102, v103, vcc
  v_add_u32 v101, v101, v102
  v_mov_b32 v106, 0
  v_or_b32 v101, s56, v101
  v_mov_b32 v107, 0
  s_mov_b32 s58, 12713984
  buffer_store_dwordx4 v[104:107], v101, s[36:39], s58 offen sc1
  s_lshr_b32 s58, s44, 2
  s_lshl_b32 s58, s58, 13
  s_and_b32 s59, s44, 3
  s_lshl_b32 s59, s59, 11
  s_add_u32 s58, s58, s59
  s_add_u32 s58, s58, 12582912
  v_or_b32 v100, s56, v2
  v_cmp_eq_u32 vcc, 0, v1
  v_mov_b32 v101, s56
  v_mov_b32 v103, 0x80000000
  v_cndmask_b32 v21, v103, v101, vcc
  buffer_store_dwordx4 v[104:107], v100, s[36:39], s58 offen sc1
  buffer_store_dwordx4 v[104:107], v100, s[36:39], s58 offen offset:1024 sc1
  s_mov_b32 s61, 0x3f803f80
  s_mov_b32 s62, 0xffff0000
  s_mov_b32 s63, 0xffff0000
  s_mov_b32 s64, 0xbdd2d3e8
  s_mov_b32 s65, 0xbdd2d3e8
  s_mov_b32 s66, 1.0
  s_mov_b32 s67, 1.0
  s_mov_b32 s68, 0x3fb8aa3b
  s_mov_b32 s69, 0x3fb8aa3b
  s_mov_b32 s70, 0x358637bd
  s_mov_b32 s71, 0x358637bd
  s_mov_b32 s75, 0xffff0000
  v_mov_b32 v26, 0xc0135761
  v_mov_b32 v27, 0xc0135761
  s_waitcnt vmcnt(0)
  v_mov_b32 v13, 1
  s_lshl_b32 s58, s44, 3
  buffer_atomic_add v13, v21, s[40:43], s58 offen sc1
  s_barrier
  s_lshl_b32 s58, s48, 9
  v_add_u32 v13, s58, v12
  ds_read_b128 v[56:59], v13 offset:0
  ds_read_b128 v[60:63], v13 offset:32
  ds_read_b128 v[64:67], v13 offset:64
  ds_read_b128 v[68:71], v13 offset:96
  ds_read_b128 v[72:75], v13 offset:128
  ds_read_b128 v[76:79], v13 offset:160
  ds_read_b128 v[80:83], v13 offset:192
  ds_read_b128 v[84:87], v13 offset:224
  v_mov_b32 v120, 0
  v_mov_b32 v121, 0
  v_mov_b32 v122, 0
  v_mov_b32 v123, 0
  ds_read_b128 v[88:91], v13 offset:256
  ds_read_b128 v[92:95], v13 offset:288
  ds_read_b128 v[96:99], v13 offset:320
  ds_read_b128 v[100:103], v13 offset:352
  ds_read_b128 v[104:107], v13 offset:384
  ds_read_b128 v[108:111], v13 offset:416
  ds_read_b128 v[112:115], v13 offset:448
  ds_read_b128 v[116:119], v13 offset:480
  s_lshl_b32 s58, s45, 7
  s_lshl_b32 s59, s48, 6
  s_add_u32 s58, s58, s59
  v_lshrrev_b32 v48, 5, v1
  v_lshlrev_b32 v48, 3, v48
  v_sub_u32 v49, v12, v48
  v_add_u32 v49, s58, v49
  s_waitcnt lgkmcnt(15)
  v_dot2c_f32_bf16 v120, s61, v56
  v_dot2c_f32_bf16 v121, v56, v56
  v_dot2c_f32_bf16 v122, s61, v57
  v_dot2c_f32_bf16 v123, v57, v57
  v_dot2c_f32_bf16 v120, s61, v58
  v_dot2c_f32_bf16 v121, v58, v58
  v_dot2c_f32_bf16 v122, s61, v59
  v_dot2c_f32_bf16 v123, v59, v59
  ds_read_b64 v[32:33], v49 offset:0
  ds_read_b64 v[34:35], v49 offset:16
  ds_read_b64 v[36:37], v49 offset:32
  ds_read_b64 v[38:39], v49 offset:48
  ds_read_b128 a[0:3], v12 offset:0
  ds_read_b128 a[4:7], v12 offset:32
  s_waitcnt lgkmcnt(15)
  v_dot2c_f32_bf16 v120, s61, v60
  v_dot2c_f32_bf16 v121, v60, v60
  v_dot2c_f32_bf16 v122, s61, v61
  v_dot2c_f32_bf16 v123, v61, v61
  v_dot2c_f32_bf16 v120, s61, v62
  v_dot2c_f32_bf16 v121, v62, v62
  v_dot2c_f32_bf16 v122, s61, v63
  v_dot2c_f32_bf16 v123, v63, v63
  ds_read_b128 a[8:11], v12 offset:64
  ds_read_b128 a[12:15], v12 offset:96
  v_dot2c_f32_bf16 v120, s61, v64
  v_dot2c_f32_bf16 v121, v64, v64
  v_dot2c_f32_bf16 v122, s61, v65
  v_dot2c_f32_bf16 v123, v65, v65
  v_dot2c_f32_bf16 v120, s61, v66
  v_dot2c_f32_bf16 v121, v66, v66
  v_dot2c_f32_bf16 v122, s61, v67
  v_dot2c_f32_bf16 v123, v67, v67
  ds_read_b128 a[16:19], v12 offset:128
  ds_read_b128 a[20:23], v12 offset:160
  v_dot2c_f32_bf16 v120, s61, v68
  v_dot2c_f32_bf16 v121, v68, v68
  v_dot2c_f32_bf16 v122, s61, v69
  v_dot2c_f32_bf16 v123, v69, v69
  v_dot2c_f32_bf16 v120, s61, v70
  v_dot2c_f32_bf16 v121, v70, v70
  v_dot2c_f32_bf16 v122, s61, v71
  v_dot2c_f32_bf16 v123, v71, v71
  ds_read_b128 a[24:27], v12 offset:192
  ds_read_b128 a[28:31], v12 offset:224
  v_dot2c_f32_bf16 v120, s61, v72
  v_dot2c_f32_bf16 v121, v72, v72
  v_dot2c_f32_bf16 v122, s61, v73
  v_dot2c_f32_bf16 v123, v73, v73
  v_dot2c_f32_bf16 v120, s61, v74
  v_dot2c_f32_bf16 v121, v74, v74
  v_dot2c_f32_bf16 v122, s61, v75
  v_dot2c_f32_bf16 v123, v75, v75
  ds_read_b128 a[32:35], v12 offset:256
  ds_read_b128 a[36:39], v12 offset:288
  v_dot2c_f32_bf16 v120, s61, v76
  v_dot2c_f32_bf16 v121, v76, v76
  v_dot2c_f32_bf16 v122, s61, v77
  v_dot2c_f32_bf16 v123, v77, v77
  v_dot2c_f32_bf16 v120, s61, v78
  v_dot2c_f32_bf16 v121, v78, v78
  v_dot2c_f32_bf16 v122, s61, v79
  v_dot2c_f32_bf16 v123, v79, v79
  ds_read_b128 a[40:43], v12 offset:320
  ds_read_b128 a[44:47], v12 offset:352
  v_dot2c_f32_bf16 v120, s61, v80
  v_dot2c_f32_bf16 v121, v80, v80
  v_dot2c_f32_bf16 v122, s61, v81
  v_dot2c_f32_bf16 v123, v81, v81
  v_dot2c_f32_bf16 v120, s61, v82
  v_dot2c_f32_bf16 v121, v82, v82
  v_dot2c_f32_bf16 v122, s61, v83
  v_dot2c_f32_bf16 v123, v83, v83
  ds_read_b128 a[48:51], v12 offset:384
  ds_read_b128 a[52:55], v12 offset:416
  s_waitcnt lgkmcnt(15)
  v_dot2c_f32_bf16 v120, s61, v84
  v_dot2c_f32_bf16 v121, v84, v84
  v_dot2c_f32_bf16 v122, s61, v85
  v_dot2c_f32_bf16 v123, v85, v85
  v_dot2c_f32_bf16 v120, s61, v86
  v_dot2c_f32_bf16 v121, v86, v86
  v_dot2c_f32_bf16 v122, s61, v87
  v_dot2c_f32_bf16 v123, v87, v87
  ds_read_b128 a[56:59], v12 offset:448
  ds_read_b128 a[60:63], v12 offset:480
  v_dot2c_f32_bf16 v120, s61, v88
  v_dot2c_f32_bf16 v121, v88, v88
  v_dot2c_f32_bf16 v122, s61, v89
  v_dot2c_f32_bf16 v123, v89, v89
  v_dot2c_f32_bf16 v120, s61, v90
  v_dot2c_f32_bf16 v121, v90, v90
  v_dot2c_f32_bf16 v122, s61, v91
  v_dot2c_f32_bf16 v123, v91, v91
  ds_read_b128 a[64:67], v12 offset:512
  ds_read_b128 a[68:71], v12 offset:544
  v_dot2c_f32_bf16 v120, s61, v92
  v_dot2c_f32_bf16 v121, v92, v92
  v_dot2c_f32_bf16 v122, s61, v93
  v_dot2c_f32_bf16 v123, v93, v93
  v_dot2c_f32_bf16 v120, s61, v94
  v_dot2c_f32_bf16 v121, v94, v94
  v_dot2c_f32_bf16 v122, s61, v95
  v_dot2c_f32_bf16 v123, v95, v95
  ds_read_b128 a[72:75], v12 offset:576
  ds_read_b128 a[76:79], v12 offset:608
  v_dot2c_f32_bf16 v120, s61, v96
  v_dot2c_f32_bf16 v121, v96, v96
  v_dot2c_f32_bf16 v122, s61, v97
  v_dot2c_f32_bf16 v123, v97, v97
  v_dot2c_f32_bf16 v120, s61, v98
  v_dot2c_f32_bf16 v121, v98, v98
  v_dot2c_f32_bf16 v122, s61, v99
  v_dot2c_f32_bf16 v123, v99, v99
  ds_read_b128 a[80:83], v12 offset:640
  ds_read_b128 a[84:87], v12 offset:672
  v_dot2c_f32_bf16 v120, s61, v100
  v_dot2c_f32_bf16 v121, v100, v100
  v_dot2c_f32_bf16 v122, s61, v101
  v_dot2c_f32_bf16 v123, v101, v101
  v_dot2c_f32_bf16 v120, s61, v102
  v_dot2c_f32_bf16 v121, v102, v102
  v_dot2c_f32_bf16 v122, s61, v103
  v_dot2c_f32_bf16 v123, v103, v103
  ds_read_b128 a[88:91], v12 offset:704
  ds_read_b128 a[92:95], v12 offset:736
  v_dot2c_f32_bf16 v120, s61, v104
  v_dot2c_f32_bf16 v121, v104, v104
  v_dot2c_f32_bf16 v122, s61, v105
  v_dot2c_f32_bf16 v123, v105, v105
  v_dot2c_f32_bf16 v120, s61, v106
  v_dot2c_f32_bf16 v121, v106, v106
  v_dot2c_f32_bf16 v122, s61, v107
  v_dot2c_f32_bf16 v123, v107, v107
  ds_read_b128 a[96:99], v12 offset:768
  ds_read_b128 a[100:103], v12 offset:800
  v_dot2c_f32_bf16 v120, s61, v108
  v_dot2c_f32_bf16 v121, v108, v108
  v_dot2c_f32_bf16 v122, s61, v109
  v_dot2c_f32_bf16 v123, v109, v109
  v_dot2c_f32_bf16 v120, s61, v110
  v_dot2c_f32_bf16 v121, v110, v110
  v_dot2c_f32_bf16 v122, s61, v111
  v_dot2c_f32_bf16 v123, v111, v111
  ds_read_b128 a[104:107], v12 offset:832
  ds_read_b128 a[108:111], v12 offset:864
  v_dot2c_f32_bf16 v120, s61, v112
  v_dot2c_f32_bf16 v121, v112, v112
  v_dot2c_f32_bf16 v122, s61, v113
  v_dot2c_f32_bf16 v123, v113, v113
  v_dot2c_f32_bf16 v120, s61, v114
  v_dot2c_f32_bf16 v121, v114, v114
  v_dot2c_f32_bf16 v122, s61, v115
  v_dot2c_f32_bf16 v123, v115, v115
  ds_read_b128 a[112:115], v12 offset:896
  ds_read_b128 a[116:119], v12 offset:928
  v_dot2c_f32_bf16 v120, s61, v116
  v_dot2c_f32_bf16 v121, v116, v116
  v_dot2c_f32_bf16 v122, s61, v117
  v_dot2c_f32_bf16 v123, v117, v117
  v_dot2c_f32_bf16 v120, s61, v118
  v_dot2c_f32_bf16 v121, v118, v118
  v_dot2c_f32_bf16 v122, s61, v119
  v_dot2c_f32_bf16 v123, v119, v119
  ds_read_b128 a[120:123], v12 offset:960
  ds_read_b128 a[124:127], v12 offset:992
  s_lshl_b32 s58, s47, 1
  s_add_u32 s58, s58, s48
  s_lshl_b32 s58, s58, 8
  s_add_u32 s58, s58, 149504
  v_and_b32 v48, 31, v1
  v_lshl_add_u32 v50, v48, 3, s58
  s_lshl_b32 s58, s47, 9
  s_add_u32 s58, s58, 149504
  v_lshl_add_u32 v51, v48, 3, s58
  v_pk_add_f32 v[120:121], v[120:121], v[122:123]
  v_mov_b32 v122, v120
  v_mov_b32 v123, v121
  s_nop 1
  v_permlane32_swap_b32 v120, v122
  v_permlane32_swap_b32 v121, v123
  s_nop 0
  v_add_f32 v120, v120, v122
  v_add_f32 v121, v121, v123
  ds_write_b64 v50, v[120:121]
  s_waitcnt lgkmcnt(0)
  s_barrier
  ds_read_b64 v[120:121], v51
  ds_read_b64 v[122:123], v51 offset:256
  s_waitcnt lgkmcnt(0)
  v_pk_add_f32 v[120:121], v[120:121], v[122:123]
  v_mul_f32 v18, 0x3b000000, v120
  v_mul_f32 v121, 0x3b000000, v121
  v_fma_f32 v121, -v18, v18, v121
  v_max_f32 v121, 0, v121
  v_add_f32 v120, 0x3727c5ac, v121
  v_rsq_f32 v20, v120
  s_nop 0
  v_mul_f32 v121, v121, v20
  v_mul_f32 v121, v121, v20
  v_add_f32 v121, 0x3727c5ac, v121
  v_rsq_f32 v121, v121
  v_mul_f32 v24, v18, v20
  v_mul_f32 v22, v20, v121
  v_sub_f32 v19, 0, v18
  s_lshl_b32 s58, s46, 8
  s_add_u32 s58, s58, 148480
  v_and_b32 v48, 31, v1
  v_lshl_add_u32 v48, v48, 2, s58
  ds_write_b32 v48, v20
  ds_write_b32 v48, v18 offset:128
  v_lshrrev_b32 v72, 4, v0
  s_lshl_b32 s58, s44, 4
  v_add_u32 v72, s58, v72
  v_bfe_u32 v73, v0, 3, 1
  v_and_b32 v74, 7, v0
  v_bfe_u32 v75, v72, 1, 1
  v_lshlrev_b32 v75, 2, v75
  v_xor_b32 v75, v75, v74
  v_mul_u32_u24 v76, 0xac0, v72
  s_mul_i32 s58, s45, 384
  v_lshl_add_u32 v76, v75, 4, v76
  v_lshl_add_u32 v76, v73, 7, v76
  v_add_u32 v76, s58, v76
  v_add_u32 v77, 0x100, v76
  v_cmp_eq_u32 vcc, 0, v73
  v_mov_b32 v78, 0x80000000
  v_lshlrev_b32 v79, 7, v72
  v_cndmask_b32 v77, v78, v77, vcc
  buffer_load_dwordx4 v[40:43], v76, s[24:27], 0 offen
  buffer_load_dwordx4 v[44:47], v77, s[24:27], 0 offen
  v_lshl_add_u32 v79, v74, 4, v79
  v_lshl_add_u32 v23, v73, 16, v79
  v_add_u32 v25, 0x20000, v23
  v_cndmask_b32 v25, v78, v25, vcc
  s_mul_i32 s81, s45, 196608
  s_add_u32 s81, s81, 14680064
  s_barrier
  ds_read_b64_tr_b16 v[88:89], v3 offset:0
  ds_read_b64_tr_b16 v[90:91], v3 offset:512
  ds_read_b64_tr_b16 v[92:93], v3 offset:2048
  ds_read_b64_tr_b16 v[94:95], v3 offset:2560
  s_waitcnt lgkmcnt(2)
  v_mfma_f32_32x32x16_bf16 v[56:71], v[88:91], a[0:3], 0
  ds_read_b64_tr_b16 v[96:97], v3 offset:4096
  ds_read_b64_tr_b16 v[98:99], v3 offset:4608
  v_mfma_f32_16x16x32_bf16 v[112:115], v[28:31], v[88:91], 0
  s_waitcnt lgkmcnt(2)
  v_mfma_f32_32x32x16_bf16 v[56:71], v[92:95], a[4:7], v[56:71]
  ds_read_b64_tr_b16 v[88:89], v3 offset:6144
  ds_read_b64_tr_b16 v[90:91], v3 offset:6656
  v_mfma_f32_16x16x32_bf16 v[112:115], v[28:31], v[92:95], v[112:115]
  s_waitcnt lgkmcnt(2)
  v_mfma_f32_32x32x16_bf16 v[56:71], v[96:99], a[8:11], v[56:71]
  ds_read_b64_tr_b16 v[92:93], v3 offset:8192
  ds_read_b64_tr_b16 v[94:95], v3 offset:8704
  v_mfma_f32_16x16x32_bf16 v[112:115], v[28:31], v[96:99], v[112:115]
  s_waitcnt lgkmcnt(2)
  v_mfma_f32_32x32x16_bf16 v[56:71], v[88:91], a[12:15], v[56:71]
  ds_read_b64_tr_b16 v[96:97], v3 offset:10240
  ds_read_b64_tr_b16 v[98:99], v3 offset:10752
  v_mfma_f32_16x16x32_bf16 v[112:115], v[28:31], v[88:91], v[112:115]
  s_waitcnt lgkmcnt(2)
  v_mfma_f32_32x32x16_bf16 v[56:71], v[92:95], a[16:19], v[56:71]
  ds_read_b64_tr_b16 v[88:89], v3 offset:12288
  ds_read_b64_tr_b16 v[90:91], v3 offset:12800
  v_mfma_f32_16x16x32_bf16 v[112:115], v[28:31], v[92:95], v[112:115]
  s_waitcnt lgkmcnt(2)
  v_mfma_f32_32x32x16_bf16 v[56:71], v[96:99], a[20:23], v[56:71]
  ds_read_b64_tr_b16 v[92:93], v3 offset:14336
  ds_read_b64_tr_b16 v[94:95], v3 offset:14848
  v_mfma_f32_16x16x32_bf16 v[112:115], v[28:31], v[96:99], v[112:115]
  s_waitcnt lgkmcnt(2)
  v_mfma_f32_32x32x16_bf16 v[56:71], v[88:91], a[24:27], v[56:71]
  s_waitcnt lgkmcnt(0)
  s_barrier
  ds_read_b64_tr_b16 v[96:97], v3 offset:16384
  ds_read_b64_tr_b16 v[98:99], v3 offset:16896
  v_mfma_f32_16x16x32_bf16 v[112:115], v[28:31], v[88:91], v[112:115]
  v_mfma_f32_32x32x16_bf16 v[56:71], v[92:95], a[28:31], v[56:71]
  ds_read_b64_tr_b16 v[88:89], v3 offset:18432
  ds_read_b64_tr_b16 v[90:91], v3 offset:18944
  v_mfma_f32_16x16x32_bf16 v[112:115], v[28:31], v[92:95], v[112:115]
  s_waitcnt lgkmcnt(2)
  v_mfma_f32_32x32x16_bf16 v[56:71], v[96:99], a[32:35], v[56:71]
  ds_read_b64_tr_b16 v[92:93], v3 offset:20480
  ds_read_b64_tr_b16 v[94:95], v3 offset:20992
  v_mfma_f32_16x16x32_bf16 v[112:115], v[28:31], v[96:99], v[112:115]
  s_waitcnt lgkmcnt(2)
  v_mfma_f32_32x32x16_bf16 v[56:71], v[88:91], a[36:39], v[56:71]
  ds_read_b64_tr_b16 v[96:97], v3 offset:22528
  ds_read_b64_tr_b16 v[98:99], v3 offset:23040
  v_mfma_f32_16x16x32_bf16 v[112:115], v[28:31], v[88:91], v[112:115]
  s_waitcnt lgkmcnt(2)
  v_mfma_f32_32x32x16_bf16 v[56:71], v[92:95], a[40:43], v[56:71]
  ds_read_b64_tr_b16 v[88:89], v3 offset:24576
  ds_read_b64_tr_b16 v[90:91], v3 offset:25088
  v_mfma_f32_16x16x32_bf16 v[112:115], v[28:31], v[92:95], v[112:115]
  s_waitcnt lgkmcnt(2)
  v_mfma_f32_32x32x16_bf16 v[56:71], v[96:99], a[44:47], v[56:71]
  ds_read_b64_tr_b16 v[92:93], v3 offset:26624
  ds_read_b64_tr_b16 v[94:95], v3 offset:27136
  v_mfma_f32_16x16x32_bf16 v[112:115], v[28:31], v[96:99], v[112:115]
  s_waitcnt lgkmcnt(2)
  v_mfma_f32_32x32x16_bf16 v[56:71], v[88:91], a[48:51], v[56:71]
  ds_read_b64_tr_b16 v[96:97], v3 offset:28672
  ds_read_b64_tr_b16 v[98:99], v3 offset:29184
  v_mfma_f32_16x16x32_bf16 v[112:115], v[28:31], v[88:91], v[112:115]
  s_waitcnt lgkmcnt(2)
  v_mfma_f32_32x32x16_bf16 v[56:71], v[92:95], a[52:55], v[56:71]
  ds_read_b64_tr_b16 v[88:89], v3 offset:30720
  ds_read_b64_tr_b16 v[90:91], v3 offset:31232
  v_mfma_f32_16x16x32_bf16 v[112:115], v[28:31], v[92:95], v[112:115]
  s_waitcnt lgkmcnt(2)
  v_mfma_f32_32x32x16_bf16 v[56:71], v[96:99], a[56:59], v[56:71]
  s_waitcnt lgkmcnt(0)
  s_barrier
  ds_read_b64_tr_b16 v[92:93], v3 offset:32768
  ds_read_b64_tr_b16 v[94:95], v3 offset:33280
  v_mfma_f32_16x16x32_bf16 v[112:115], v[28:31], v[96:99], v[112:115]
  v_mfma_f32_32x32x16_bf16 v[56:71], v[88:91], a[60:63], v[56:71]
  ds_read_b64_tr_b16 v[96:97], v3 offset:34816
  ds_read_b64_tr_b16 v[98:99], v3 offset:35328
  v_mfma_f32_16x16x32_bf16 v[112:115], v[28:31], v[88:91], v[112:115]
  s_waitcnt lgkmcnt(2)
  v_mfma_f32_32x32x16_bf16 v[56:71], v[92:95], a[64:67], v[56:71]
  ds_read_b64_tr_b16 v[88:89], v3 offset:36864
  ds_read_b64_tr_b16 v[90:91], v3 offset:37376
  v_mfma_f32_16x16x32_bf16 v[112:115], v[28:31], v[92:95], v[112:115]
  s_waitcnt lgkmcnt(2)
  v_mfma_f32_32x32x16_bf16 v[56:71], v[96:99], a[68:71], v[56:71]
  ds_read_b64_tr_b16 v[92:93], v3 offset:38912
  ds_read_b64_tr_b16 v[94:95], v3 offset:39424
  v_mfma_f32_16x16x32_bf16 v[112:115], v[28:31], v[96:99], v[112:115]
  s_waitcnt lgkmcnt(2)
  v_mfma_f32_32x32x16_bf16 v[56:71], v[88:91], a[72:75], v[56:71]
  ds_read_b64_tr_b16 v[96:97], v3 offset:40960
  ds_read_b64_tr_b16 v[98:99], v3 offset:41472
  v_mfma_f32_16x16x32_bf16 v[112:115], v[28:31], v[88:91], v[112:115]
  s_waitcnt lgkmcnt(2)
  v_mfma_f32_32x32x16_bf16 v[56:71], v[92:95], a[76:79], v[56:71]
  ds_read_b64_tr_b16 v[88:89], v3 offset:43008
  ds_read_b64_tr_b16 v[90:91], v3 offset:43520
  v_mfma_f32_16x16x32_bf16 v[112:115], v[28:31], v[92:95], v[112:115]
  s_waitcnt lgkmcnt(2)
  v_mfma_f32_32x32x16_bf16 v[56:71], v[96:99], a[80:83], v[56:71]
  ds_read_b64_tr_b16 v[92:93], v3 offset:45056
  ds_read_b64_tr_b16 v[94:95], v3 offset:45568
  v_mfma_f32_16x16x32_bf16 v[112:115], v[28:31], v[96:99], v[112:115]
  s_waitcnt lgkmcnt(2)
  v_mfma_f32_32x32x16_bf16 v[56:71], v[88:91], a[84:87], v[56:71]
  ds_read_b64_tr_b16 v[96:97], v3 offset:47104
  ds_read_b64_tr_b16 v[98:99], v3 offset:47616
  v_mfma_f32_16x16x32_bf16 v[112:115], v[28:31], v[88:91], v[112:115]
  s_waitcnt lgkmcnt(2)
  v_mfma_f32_32x32x16_bf16 v[56:71], v[92:95], a[88:91], v[56:71]
  s_waitcnt lgkmcnt(0)
  s_barrier
  ds_read_b64_tr_b16 v[88:89], v3 offset:49152
  ds_read_b64_tr_b16 v[90:91], v3 offset:49664
  v_mfma_f32_16x16x32_bf16 v[112:115], v[28:31], v[92:95], v[112:115]
  v_mfma_f32_32x32x16_bf16 v[56:71], v[96:99], a[92:95], v[56:71]
  ds_read_b64_tr_b16 v[92:93], v3 offset:51200
  ds_read_b64_tr_b16 v[94:95], v3 offset:51712
  v_mfma_f32_16x16x32_bf16 v[112:115], v[28:31], v[96:99], v[112:115]
  s_waitcnt lgkmcnt(2)
  v_mfma_f32_32x32x16_bf16 v[56:71], v[88:91], a[96:99], v[56:71]
  ds_read_b64_tr_b16 v[96:97], v3 offset:53248
  ds_read_b64_tr_b16 v[98:99], v3 offset:53760
  v_mfma_f32_16x16x32_bf16 v[112:115], v[28:31], v[88:91], v[112:115]
  s_waitcnt lgkmcnt(2)
  v_mfma_f32_32x32x16_bf16 v[56:71], v[92:95], a[100:103], v[56:71]
  ds_read_b64_tr_b16 v[88:89], v3 offset:55296
  ds_read_b64_tr_b16 v[90:91], v3 offset:55808
  v_mfma_f32_16x16x32_bf16 v[112:115], v[28:31], v[92:95], v[112:115]
  s_waitcnt lgkmcnt(2)
  v_mfma_f32_32x32x16_bf16 v[56:71], v[96:99], a[104:107], v[56:71]
  ds_read_b64_tr_b16 v[92:93], v3 offset:57344
  ds_read_b64_tr_b16 v[94:95], v3 offset:57856
  v_mfma_f32_16x16x32_bf16 v[112:115], v[28:31], v[96:99], v[112:115]
  s_waitcnt lgkmcnt(2)
  v_mfma_f32_32x32x16_bf16 v[56:71], v[88:91], a[108:111], v[56:71]
  ds_read_b64_tr_b16 v[96:97], v3 offset:59392
  ds_read_b64_tr_b16 v[98:99], v3 offset:59904
  v_mfma_f32_16x16x32_bf16 v[112:115], v[28:31], v[88:91], v[112:115]
  s_waitcnt lgkmcnt(2)
  v_mfma_f32_32x32x16_bf16 v[56:71], v[92:95], a[112:115], v[56:71]
  ds_read_b64_tr_b16 v[88:89], v3 offset:61440
  ds_read_b64_tr_b16 v[90:91], v3 offset:61952
  v_mfma_f32_16x16x32_bf16 v[112:115], v[28:31], v[92:95], v[112:115]
  s_waitcnt lgkmcnt(2)
  v_mfma_f32_32x32x16_bf16 v[56:71], v[96:99], a[116:119], v[56:71]
  ds_read_b64_tr_b16 v[92:93], v3 offset:63488
  ds_read_b64_tr_b16 v[94:95], v3 offset:64000
  v_mfma_f32_16x16x32_bf16 v[112:115], v[28:31], v[96:99], v[112:115]
  s_waitcnt lgkmcnt(2)
  v_mfma_f32_32x32x16_bf16 v[56:71], v[88:91], a[120:123], v[56:71]
  v_mfma_f32_16x16x32_bf16 v[112:115], v[28:31], v[88:91], v[112:115]
  s_waitcnt lgkmcnt(0)
  v_mfma_f32_32x32x16_bf16 v[56:71], v[92:95], a[124:127], v[56:71]
  v_mfma_f32_16x16x32_bf16 v[112:115], v[28:31], v[92:95], v[112:115]
  s_barrier
  s_nop 10
  v_fmac_f32_dpp v56, v112, v19 row_newbcast:0 row_mask:0x3 bank_mask:0xf
  v_fmac_f32_dpp v56, v112, v19 row_newbcast:4 row_mask:0xc bank_mask:0xf
  v_fmac_f32_dpp v57, v112, v19 row_newbcast:1 row_mask:0x3 bank_mask:0xf
  v_fmac_f32_dpp v57, v112, v19 row_newbcast:5 row_mask:0xc bank_mask:0xf
  v_fmac_f32_dpp v58, v112, v19 row_newbcast:2 row_mask:0x3 bank_mask:0xf
  v_fmac_f32_dpp v58, v112, v19 row_newbcast:6 row_mask:0xc bank_mask:0xf
  v_fmac_f32_dpp v59, v112, v19 row_newbcast:3 row_mask:0x3 bank_mask:0xf
  v_fmac_f32_dpp v59, v112, v19 row_newbcast:7 row_mask:0xc bank_mask:0xf
  v_fmac_f32_dpp v60, v112, v19 row_newbcast:8 row_mask:0x3 bank_mask:0xf
  v_fmac_f32_dpp v60, v112, v19 row_newbcast:12 row_mask:0xc bank_mask:0xf
  v_fmac_f32_dpp v61, v112, v19 row_newbcast:9 row_mask:0x3 bank_mask:0xf
  v_fmac_f32_dpp v61, v112, v19 row_newbcast:13 row_mask:0xc bank_mask:0xf
  v_fmac_f32_dpp v62, v112, v19 row_newbcast:10 row_mask:0x3 bank_mask:0xf
  v_fmac_f32_dpp v62, v112, v19 row_newbcast:14 row_mask:0xc bank_mask:0xf
  v_fmac_f32_dpp v63, v112, v19 row_newbcast:11 row_mask:0x3 bank_mask:0xf
  v_fmac_f32_dpp v63, v112, v19 row_newbcast:15 row_mask:0xc bank_mask:0xf
  v_fmac_f32_dpp v64, v113, v19 row_newbcast:0 row_mask:0x3 bank_mask:0xf
  v_fmac_f32_dpp v64, v113, v19 row_newbcast:4 row_mask:0xc bank_mask:0xf
  v_fmac_f32_dpp v65, v113, v19 row_newbcast:1 row_mask:0x3 bank_mask:0xf
  v_fmac_f32_dpp v65, v113, v19 row_newbcast:5 row_mask:0xc bank_mask:0xf
  v_fmac_f32_dpp v66, v113, v19 row_newbcast:2 row_mask:0x3 bank_mask:0xf
  v_fmac_f32_dpp v66, v113, v19 row_newbcast:6 row_mask:0xc bank_mask:0xf
  v_fmac_f32_dpp v67, v113, v19 row_newbcast:3 row_mask:0x3 bank_mask:0xf
  v_fmac_f32_dpp v67, v113, v19 row_newbcast:7 row_mask:0xc bank_mask:0xf
  v_fmac_f32_dpp v68, v113, v19 row_newbcast:8 row_mask:0x3 bank_mask:0xf
  v_fmac_f32_dpp v68, v113, v19 row_newbcast:12 row_mask:0xc bank_mask:0xf
  v_fmac_f32_dpp v69, v113, v19 row_newbcast:9 row_mask:0x3 bank_mask:0xf
  v_fmac_f32_dpp v69, v113, v19 row_newbcast:13 row_mask:0xc bank_mask:0xf
  v_fmac_f32_dpp v70, v113, v19 row_newbcast:10 row_mask:0x3 bank_mask:0xf
  v_fmac_f32_dpp v70, v113, v19 row_newbcast:14 row_mask:0xc bank_mask:0xf
  v_fmac_f32_dpp v71, v113, v19 row_newbcast:11 row_mask:0x3 bank_mask:0xf
  v_fmac_f32_dpp v71, v113, v19 row_newbcast:15 row_mask:0xc bank_mask:0xf
  v_pk_mul_f32 v[56:57], v[56:57], v[22:23] op_sel_hi:[1,0]
  v_pk_mul_f32 v[58:59], v[58:59], v[22:23] op_sel_hi:[1,0]
  v_pk_mul_f32 v[60:61], v[60:61], v[22:23] op_sel_hi:[1,0]
  v_pk_mul_f32 v[62:63], v[62:63], v[22:23] op_sel_hi:[1,0]
  v_pk_mul_f32 v[64:65], v[64:65], v[22:23] op_sel_hi:[1,0]
  v_pk_mul_f32 v[66:67], v[66:67], v[22:23] op_sel_hi:[1,0]
  v_pk_mul_f32 v[68:69], v[68:69], v[22:23] op_sel_hi:[1,0]
  v_pk_mul_f32 v[70:71], v[70:71], v[22:23] op_sel_hi:[1,0]
  v_pk_mul_f32 v[88:89], v[56:57], v[56:57]
  v_pk_mul_f32 v[90:91], v[58:59], v[58:59]
  v_pk_mul_f32 v[92:93], v[60:61], v[60:61]
  v_pk_mul_f32 v[94:95], v[62:63], v[62:63]
  v_pk_mul_f32 v[96:97], v[64:65], v[64:65]
  v_pk_mul_f32 v[98:99], v[66:67], v[66:67]
  v_pk_mul_f32 v[100:101], v[68:69], v[68:69]
  v_pk_mul_f32 v[102:103], v[70:71], v[70:71]
  v_pk_fma_f32 v[88:89], v[88:89], s[64:65], v[26:27]
  v_pk_fma_f32 v[90:91], v[90:91], s[64:65], v[26:27]
  v_pk_fma_f32 v[92:93], v[92:93], s[64:65], v[26:27]
  v_pk_fma_f32 v[94:95], v[94:95], s[64:65], v[26:27]
  v_pk_fma_f32 v[96:97], v[96:97], s[64:65], v[26:27]
  v_pk_fma_f32 v[98:99], v[98:99], s[64:65], v[26:27]
  v_pk_fma_f32 v[100:101], v[100:101], s[64:65], v[26:27]
  v_pk_fma_f32 v[102:103], v[102:103], s[64:65], v[26:27]
  v_pk_mul_f32 v[88:89], v[88:89], v[56:57]
  v_pk_mul_f32 v[90:91], v[90:91], v[58:59]
  v_pk_mul_f32 v[92:93], v[92:93], v[60:61]
  v_pk_mul_f32 v[94:95], v[94:95], v[62:63]
  v_pk_mul_f32 v[96:97], v[96:97], v[64:65]
  v_pk_mul_f32 v[98:99], v[98:99], v[66:67]
  v_pk_mul_f32 v[100:101], v[100:101], v[68:69]
  v_pk_mul_f32 v[102:103], v[102:103], v[70:71]
  v_exp_f32 v88, v88
  v_exp_f32 v89, v89
  v_exp_f32 v90, v90
  v_exp_f32 v91, v91
  v_exp_f32 v92, v92
  v_exp_f32 v93, v93
  v_exp_f32 v94, v94
  v_exp_f32 v95, v95
  v_exp_f32 v96, v96
  v_exp_f32 v97, v97
  v_exp_f32 v98, v98
  v_exp_f32 v99, v99
  v_exp_f32 v100, v100
  v_exp_f32 v101, v101
  v_exp_f32 v102, v102
  v_exp_f32 v103, v103
  v_pk_add_f32 v[88:89], v[88:89], s[66:67]
  v_pk_add_f32 v[90:91], v[90:91], s[66:67]
  v_pk_add_f32 v[92:93], v[92:93], s[66:67]
  v_pk_add_f32 v[94:95], v[94:95], s[66:67]
  v_pk_add_f32 v[96:97], v[96:97], s[66:67]
  v_pk_add_f32 v[98:99], v[98:99], s[66:67]
  v_pk_add_f32 v[100:101], v[100:101], s[66:67]
  v_pk_add_f32 v[102:103], v[102:103], s[66:67]
  v_rcp_f32 v88, v88
  v_rcp_f32 v89, v89
  v_rcp_f32 v90, v90
  v_rcp_f32 v91, v91
  v_rcp_f32 v92, v92
  v_rcp_f32 v93, v93
  v_rcp_f32 v94, v94
  v_rcp_f32 v95, v95
  v_rcp_f32 v96, v96
  v_rcp_f32 v97, v97
  v_rcp_f32 v98, v98
  v_rcp_f32 v99, v99
  v_rcp_f32 v100, v100
  v_rcp_f32 v101, v101
  v_rcp_f32 v102, v102
  v_rcp_f32 v103, v103
  v_pk_mul_f32 v[56:57], v[56:57], v[88:89]
  v_pk_mul_f32 v[58:59], v[58:59], v[90:91]
  v_pk_mul_f32 v[60:61], v[60:61], v[92:93]
  v_pk_mul_f32 v[62:63], v[62:63], v[94:95]
  v_pk_mul_f32 v[64:65], v[64:65], v[96:97]
  v_pk_mul_f32 v[66:67], v[66:67], v[98:99]
  v_pk_mul_f32 v[68:69], v[68:69], v[100:101]
  v_pk_mul_f32 v[70:71], v[70:71], v[102:103]
  v_cvt_pk_bf16_f32 v120, v56, v57
  v_cvt_pk_bf16_f32 v121, v58, v59
  v_cvt_pk_bf16_f32 v122, v60, v61
  v_cvt_pk_bf16_f32 v123, v62, v63
  v_cvt_pk_bf16_f32 v124, v64, v65
  v_cvt_pk_bf16_f32 v125, v66, v67
  v_cvt_pk_bf16_f32 v126, v68, v69
  v_cvt_pk_bf16_f32 v127, v70, v71
  s_mul_i32 s58, s60, 32768
  s_mul_i32 s59, s82, 4096
  s_add_u32 s58, s58, s59
  s_lshl_b32 s59, s48, 11
  s_add_u32 s58, s58, s59
  s_add_u32 s58, s58, 0
  buffer_store_dwordx4 v[120:123], v2, s[36:39], s58 offen sc1
  buffer_store_dwordx4 v[124:127], v2, s[36:39], s58 offen offset:1024 sc1
  s_barrier
  ds_read_b64_tr_b16 v[88:89], v4 offset:0
  ds_read_b64_tr_b16 v[90:91], v4 offset:512
  ds_read_b64_tr_b16 v[92:93], v4 offset:2048
  ds_read_b64_tr_b16 v[94:95], v4 offset:2560
  s_waitcnt lgkmcnt(2)
  v_mfma_f32_32x32x16_bf16 v[56:71], v[88:91], a[0:3], 0
  ds_read_b64_tr_b16 v[96:97], v4 offset:4096
  ds_read_b64_tr_b16 v[98:99], v4 offset:4608
  v_mfma_f32_16x16x32_bf16 v[112:115], v[28:31], v[88:91], 0
  s_waitcnt lgkmcnt(2)
  v_mfma_f32_32x32x16_bf16 v[56:71], v[92:95], a[4:7], v[56:71]
  ds_read_b64_tr_b16 v[88:89], v4 offset:6144
  ds_read_b64_tr_b16 v[90:91], v4 offset:6656
  v_mfma_f32_16x16x32_bf16 v[112:115], v[28:31], v[92:95], v[112:115]
  s_waitcnt lgkmcnt(2)
  v_mfma_f32_32x32x16_bf16 v[56:71], v[96:99], a[8:11], v[56:71]
  ds_read_b64_tr_b16 v[92:93], v4 offset:8192
  ds_read_b64_tr_b16 v[94:95], v4 offset:8704
  v_mfma_f32_16x16x32_bf16 v[112:115], v[28:31], v[96:99], v[112:115]
  s_waitcnt lgkmcnt(2)
  v_mfma_f32_32x32x16_bf16 v[56:71], v[88:91], a[12:15], v[56:71]
  ds_read_b64_tr_b16 v[96:97], v4 offset:10240
  ds_read_b64_tr_b16 v[98:99], v4 offset:10752
  v_mfma_f32_16x16x32_bf16 v[112:115], v[28:31], v[88:91], v[112:115]
  s_waitcnt lgkmcnt(2)
  v_mfma_f32_32x32x16_bf16 v[56:71], v[92:95], a[16:19], v[56:71]
  ds_read_b64_tr_b16 v[88:89], v4 offset:12288
  ds_read_b64_tr_b16 v[90:91], v4 offset:12800
  v_mfma_f32_16x16x32_bf16 v[112:115], v[28:31], v[92:95], v[112:115]
  s_waitcnt lgkmcnt(2)
  v_mfma_f32_32x32x16_bf16 v[56:71], v[96:99], a[20:23], v[56:71]
  ds_read_b64_tr_b16 v[92:93], v4 offset:14336
  ds_read_b64_tr_b16 v[94:95], v4 offset:14848
  v_mfma_f32_16x16x32_bf16 v[112:115], v[28:31], v[96:99], v[112:115]
  s_waitcnt lgkmcnt(2)
  v_mfma_f32_32x32x16_bf16 v[56:71], v[88:91], a[24:27], v[56:71]
  s_waitcnt lgkmcnt(0)
  s_waitcnt vmcnt(0)
  s_barrier
  s_lshl_b32 s76, s44, 7
  s_lshl_b32 s77, s45, 2
  s_add_u32 s76, s76, s77
  s_add_u32 s76, s76, 12713984
  v_mov_b32 v13, 1
  buffer_store_dword v13, v14, s[36:39], s76 offen sc1
  ds_read_b64_tr_b16 v[96:97], v4 offset:16384
  ds_read_b64_tr_b16 v[98:99], v4 offset:16896
  v_mfma_f32_16x16x32_bf16 v[112:115], v[28:31], v[88:91], v[112:115]
  v_mfma_f32_32x32x16_bf16 v[56:71], v[92:95], a[28:31], v[56:71]
  ds_read_b64_tr_b16 v[88:89], v4 offset:18432
  ds_read_b64_tr_b16 v[90:91], v4 offset:18944
  v_mfma_f32_16x16x32_bf16 v[112:115], v[28:31], v[92:95], v[112:115]
  s_waitcnt lgkmcnt(2)
  v_mfma_f32_32x32x16_bf16 v[56:71], v[96:99], a[32:35], v[56:71]
  ds_read_b64_tr_b16 v[92:93], v4 offset:20480
  ds_read_b64_tr_b16 v[94:95], v4 offset:20992
  v_mfma_f32_16x16x32_bf16 v[112:115], v[28:31], v[96:99], v[112:115]
  s_waitcnt lgkmcnt(2)
  v_mfma_f32_32x32x16_bf16 v[56:71], v[88:91], a[36:39], v[56:71]
  ds_read_b64_tr_b16 v[96:97], v4 offset:22528
  ds_read_b64_tr_b16 v[98:99], v4 offset:23040
  v_mfma_f32_16x16x32_bf16 v[112:115], v[28:31], v[88:91], v[112:115]
  s_waitcnt lgkmcnt(2)
  v_mfma_f32_32x32x16_bf16 v[56:71], v[92:95], a[40:43], v[56:71]
  ds_read_b64_tr_b16 v[88:89], v4 offset:24576
  ds_read_b64_tr_b16 v[90:91], v4 offset:25088
  v_mfma_f32_16x16x32_bf16 v[112:115], v[28:31], v[92:95], v[112:115]
  s_waitcnt lgkmcnt(2)
  v_mfma_f32_32x32x16_bf16 v[56:71], v[96:99], a[44:47], v[56:71]
  ds_read_b64_tr_b16 v[92:93], v4 offset:26624
  ds_read_b64_tr_b16 v[94:95], v4 offset:27136
  v_mfma_f32_16x16x32_bf16 v[112:115], v[28:31], v[96:99], v[112:115]
  s_waitcnt lgkmcnt(2)
  v_mfma_f32_32x32x16_bf16 v[56:71], v[88:91], a[48:51], v[56:71]
  ds_read_b64_tr_b16 v[96:97], v4 offset:28672
  ds_read_b64_tr_b16 v[98:99], v4 offset:29184
  v_mfma_f32_16x16x32_bf16 v[112:115], v[28:31], v[88:91], v[112:115]
  s_waitcnt lgkmcnt(2)
  v_mfma_f32_32x32x16_bf16 v[56:71], v[92:95], a[52:55], v[56:71]
  ds_read_b64_tr_b16 v[88:89], v4 offset:30720
  ds_read_b64_tr_b16 v[90:91], v4 offset:31232
  v_mfma_f32_16x16x32_bf16 v[112:115], v[28:31], v[92:95], v[112:115]
  s_waitcnt lgkmcnt(2)
  v_mfma_f32_32x32x16_bf16 v[56:71], v[96:99], a[56:59], v[56:71]
  s_waitcnt lgkmcnt(0)
  s_barrier
  ds_read_b64_tr_b16 v[92:93], v4 offset:32768
  ds_read_b64_tr_b16 v[94:95], v4 offset:33280
  v_mfma_f32_16x16x32_bf16 v[112:115], v[28:31], v[96:99], v[112:115]
  v_mfma_f32_32x32x16_bf16 v[56:71], v[88:91], a[60:63], v[56:71]
  ds_read_b64_tr_b16 v[96:97], v4 offset:34816
  ds_read_b64_tr_b16 v[98:99], v4 offset:35328
  v_mfma_f32_16x16x32_bf16 v[112:115], v[28:31], v[88:91], v[112:115]
  s_waitcnt lgkmcnt(2)
  v_mfma_f32_32x32x16_bf16 v[56:71], v[92:95], a[64:67], v[56:71]
  ds_read_b64_tr_b16 v[88:89], v4 offset:36864
  ds_read_b64_tr_b16 v[90:91], v4 offset:37376
  v_mfma_f32_16x16x32_bf16 v[112:115], v[28:31], v[92:95], v[112:115]
  s_waitcnt lgkmcnt(2)
  v_mfma_f32_32x32x16_bf16 v[56:71], v[96:99], a[68:71], v[56:71]
  ds_read_b64_tr_b16 v[92:93], v4 offset:38912
  ds_read_b64_tr_b16 v[94:95], v4 offset:39424
  v_mfma_f32_16x16x32_bf16 v[112:115], v[28:31], v[96:99], v[112:115]
  s_waitcnt lgkmcnt(2)
  v_mfma_f32_32x32x16_bf16 v[56:71], v[88:91], a[72:75], v[56:71]
  ds_read_b64_tr_b16 v[96:97], v4 offset:40960
  ds_read_b64_tr_b16 v[98:99], v4 offset:41472
  v_mfma_f32_16x16x32_bf16 v[112:115], v[28:31], v[88:91], v[112:115]
  s_waitcnt lgkmcnt(2)
  v_mfma_f32_32x32x16_bf16 v[56:71], v[92:95], a[76:79], v[56:71]
  ds_read_b64_tr_b16 v[88:89], v4 offset:43008
  ds_read_b64_tr_b16 v[90:91], v4 offset:43520
  v_mfma_f32_16x16x32_bf16 v[112:115], v[28:31], v[92:95], v[112:115]
  s_waitcnt lgkmcnt(2)
  v_mfma_f32_32x32x16_bf16 v[56:71], v[96:99], a[80:83], v[56:71]
  ds_read_b64_tr_b16 v[92:93], v4 offset:45056
  ds_read_b64_tr_b16 v[94:95], v4 offset:45568
  v_mfma_f32_16x16x32_bf16 v[112:115], v[28:31], v[96:99], v[112:115]
  s_waitcnt lgkmcnt(2)
  v_mfma_f32_32x32x16_bf16 v[56:71], v[88:91], a[84:87], v[56:71]
  ds_read_b64_tr_b16 v[96:97], v4 offset:47104
  ds_read_b64_tr_b16 v[98:99], v4 offset:47616
  v_mfma_f32_16x16x32_bf16 v[112:115], v[28:31], v[88:91], v[112:115]
  s_waitcnt lgkmcnt(2)
  v_mfma_f32_32x32x16_bf16 v[56:71], v[92:95], a[88:91], v[56:71]
  s_waitcnt lgkmcnt(0)
  s_barrier
  ds_read_b64_tr_b16 v[88:89], v4 offset:49152
  ds_read_b64_tr_b16 v[90:91], v4 offset:49664
  v_mfma_f32_16x16x32_bf16 v[112:115], v[28:31], v[92:95], v[112:115]
  v_mfma_f32_32x32x16_bf16 v[56:71], v[96:99], a[92:95], v[56:71]
  ds_read_b64_tr_b16 v[92:93], v4 offset:51200
  ds_read_b64_tr_b16 v[94:95], v4 offset:51712
  v_mfma_f32_16x16x32_bf16 v[112:115], v[28:31], v[96:99], v[112:115]
  s_waitcnt lgkmcnt(2)
  v_mfma_f32_32x32x16_bf16 v[56:71], v[88:91], a[96:99], v[56:71]
  ds_read_b64_tr_b16 v[96:97], v4 offset:53248
  ds_read_b64_tr_b16 v[98:99], v4 offset:53760
  v_mfma_f32_16x16x32_bf16 v[112:115], v[28:31], v[88:91], v[112:115]
  s_waitcnt lgkmcnt(2)
  v_mfma_f32_32x32x16_bf16 v[56:71], v[92:95], a[100:103], v[56:71]
  ds_read_b64_tr_b16 v[88:89], v4 offset:55296
  ds_read_b64_tr_b16 v[90:91], v4 offset:55808
  v_mfma_f32_16x16x32_bf16 v[112:115], v[28:31], v[92:95], v[112:115]
  s_waitcnt lgkmcnt(2)
  v_mfma_f32_32x32x16_bf16 v[56:71], v[96:99], a[104:107], v[56:71]
  ds_read_b64_tr_b16 v[92:93], v4 offset:57344
  ds_read_b64_tr_b16 v[94:95], v4 offset:57856
  v_mfma_f32_16x16x32_bf16 v[112:115], v[28:31], v[96:99], v[112:115]
  s_waitcnt lgkmcnt(2)
  v_mfma_f32_32x32x16_bf16 v[56:71], v[88:91], a[108:111], v[56:71]
  ds_read_b64_tr_b16 v[96:97], v4 offset:59392
  ds_read_b64_tr_b16 v[98:99], v4 offset:59904
  v_mfma_f32_16x16x32_bf16 v[112:115], v[28:31], v[88:91], v[112:115]
  s_waitcnt lgkmcnt(2)
  v_mfma_f32_32x32x16_bf16 v[56:71], v[92:95], a[112:115], v[56:71]
  ds_read_b64_tr_b16 v[88:89], v4 offset:61440
  ds_read_b64_tr_b16 v[90:91], v4 offset:61952
  v_mfma_f32_16x16x32_bf16 v[112:115], v[28:31], v[92:95], v[112:115]
  s_waitcnt lgkmcnt(2)
  v_mfma_f32_32x32x16_bf16 v[56:71], v[96:99], a[116:119], v[56:71]
  ds_read_b64_tr_b16 v[92:93], v4 offset:63488
  ds_read_b64_tr_b16 v[94:95], v4 offset:64000
  v_mfma_f32_16x16x32_bf16 v[112:115], v[28:31], v[96:99], v[112:115]
  s_waitcnt lgkmcnt(2)
  v_mfma_f32_32x32x16_bf16 v[56:71], v[88:91], a[120:123], v[56:71]
  v_mfma_f32_16x16x32_bf16 v[112:115], v[28:31], v[88:91], v[112:115]
  s_waitcnt lgkmcnt(0)
  v_mfma_f32_32x32x16_bf16 v[56:71], v[92:95], a[124:127], v[56:71]
  v_mfma_f32_16x16x32_bf16 v[112:115], v[28:31], v[92:95], v[112:115]
  s_barrier
  buffer_store_dwordx4 v[40:43], v23, s[36:39], s81 offen sc1
  buffer_store_dwordx4 v[44:47], v25, s[36:39], s81 offen sc1
  s_nop 10
  v_fmac_f32_dpp v56, v112, v19 row_newbcast:0 row_mask:0x3 bank_mask:0xf
  v_fmac_f32_dpp v56, v112, v19 row_newbcast:4 row_mask:0xc bank_mask:0xf
  v_fmac_f32_dpp v57, v112, v19 row_newbcast:1 row_mask:0x3 bank_mask:0xf
  v_fmac_f32_dpp v57, v112, v19 row_newbcast:5 row_mask:0xc bank_mask:0xf
  v_fmac_f32_dpp v58, v112, v19 row_newbcast:2 row_mask:0x3 bank_mask:0xf
  v_fmac_f32_dpp v58, v112, v19 row_newbcast:6 row_mask:0xc bank_mask:0xf
  v_fmac_f32_dpp v59, v112, v19 row_newbcast:3 row_mask:0x3 bank_mask:0xf
  v_fmac_f32_dpp v59, v112, v19 row_newbcast:7 row_mask:0xc bank_mask:0xf
  v_fmac_f32_dpp v60, v112, v19 row_newbcast:8 row_mask:0x3 bank_mask:0xf
  v_fmac_f32_dpp v60, v112, v19 row_newbcast:12 row_mask:0xc bank_mask:0xf
  v_fmac_f32_dpp v61, v112, v19 row_newbcast:9 row_mask:0x3 bank_mask:0xf
  v_fmac_f32_dpp v61, v112, v19 row_newbcast:13 row_mask:0xc bank_mask:0xf
  v_fmac_f32_dpp v62, v112, v19 row_newbcast:10 row_mask:0x3 bank_mask:0xf
  v_fmac_f32_dpp v62, v112, v19 row_newbcast:14 row_mask:0xc bank_mask:0xf
  v_fmac_f32_dpp v63, v112, v19 row_newbcast:11 row_mask:0x3 bank_mask:0xf
  v_fmac_f32_dpp v63, v112, v19 row_newbcast:15 row_mask:0xc bank_mask:0xf
  v_fmac_f32_dpp v64, v113, v19 row_newbcast:0 row_mask:0x3 bank_mask:0xf
  v_fmac_f32_dpp v64, v113, v19 row_newbcast:4 row_mask:0xc bank_mask:0xf
  v_fmac_f32_dpp v65, v113, v19 row_newbcast:1 row_mask:0x3 bank_mask:0xf
  v_fmac_f32_dpp v65, v113, v19 row_newbcast:5 row_mask:0xc bank_mask:0xf
  v_fmac_f32_dpp v66, v113, v19 row_newbcast:2 row_mask:0x3 bank_mask:0xf
  v_fmac_f32_dpp v66, v113, v19 row_newbcast:6 row_mask:0xc bank_mask:0xf
  v_fmac_f32_dpp v67, v113, v19 row_newbcast:3 row_mask:0x3 bank_mask:0xf
  v_fmac_f32_dpp v67, v113, v19 row_newbcast:7 row_mask:0xc bank_mask:0xf
  v_fmac_f32_dpp v68, v113, v19 row_newbcast:8 row_mask:0x3 bank_mask:0xf
  v_fmac_f32_dpp v68, v113, v19 row_newbcast:12 row_mask:0xc bank_mask:0xf
  v_fmac_f32_dpp v69, v113, v19 row_newbcast:9 row_mask:0x3 bank_mask:0xf
  v_fmac_f32_dpp v69, v113, v19 row_newbcast:13 row_mask:0xc bank_mask:0xf
  v_fmac_f32_dpp v70, v113, v19 row_newbcast:10 row_mask:0x3 bank_mask:0xf
  v_fmac_f32_dpp v70, v113, v19 row_newbcast:14 row_mask:0xc bank_mask:0xf
  v_fmac_f32_dpp v71, v113, v19 row_newbcast:11 row_mask:0x3 bank_mask:0xf
  v_fmac_f32_dpp v71, v113, v19 row_newbcast:15 row_mask:0xc bank_mask:0xf
  v_pk_mul_f32 v[56:57], v[56:57], v[20:21] op_sel_hi:[1,0]
  v_pk_mul_f32 v[58:59], v[58:59], v[20:21] op_sel_hi:[1,0]
  v_pk_mul_f32 v[60:61], v[60:61], v[20:21] op_sel_hi:[1,0]
  v_pk_mul_f32 v[62:63], v[62:63], v[20:21] op_sel_hi:[1,0]
  v_pk_mul_f32 v[64:65], v[64:65], v[20:21] op_sel_hi:[1,0]
  v_pk_mul_f32 v[66:67], v[66:67], v[20:21] op_sel_hi:[1,0]
  v_pk_mul_f32 v[68:69], v[68:69], v[20:21] op_sel_hi:[1,0]
  v_pk_mul_f32 v[70:71], v[70:71], v[20:21] op_sel_hi:[1,0]
  v_pk_mul_f32 v[88:89], v[56:57], s[68:69]
  v_pk_mul_f32 v[90:91], v[58:59], s[68:69]
  v_pk_mul_f32 v[92:93], v[60:61], s[68:69]
  v_pk_mul_f32 v[94:95], v[62:63], s[68:69]
  v_pk_mul_f32 v[96:97], v[64:65], s[68:69]
  v_pk_mul_f32 v[98:99], v[66:67], s[68:69]
  v_pk_mul_f32 v[100:101], v[68:69], s[68:69]
  v_pk_mul_f32 v[102:103], v[70:71], s[68:69]
  v_min_f32 v88, 0, v88
  v_min_f32 v89, 0, v89
  v_min_f32 v90, 0, v90
  v_min_f32 v91, 0, v91
  v_min_f32 v92, 0, v92
  v_min_f32 v93, 0, v93
  v_min_f32 v94, 0, v94
  v_min_f32 v95, 0, v95
  v_min_f32 v96, 0, v96
  v_min_f32 v97, 0, v97
  v_min_f32 v98, 0, v98
  v_min_f32 v99, 0, v99
  v_min_f32 v100, 0, v100
  v_min_f32 v101, 0, v101
  v_min_f32 v102, 0, v102
  v_min_f32 v103, 0, v103
  v_exp_f32 v88, v88
  v_exp_f32 v89, v89
  v_exp_f32 v90, v90
  v_exp_f32 v91, v91
  v_exp_f32 v92, v92
  v_exp_f32 v93, v93
  v_exp_f32 v94, v94
  v_exp_f32 v95, v95
  v_exp_f32 v96, v96
  v_exp_f32 v97, v97
  v_exp_f32 v98, v98
  v_exp_f32 v99, v99
  v_exp_f32 v100, v100
  v_exp_f32 v101, v101
  v_exp_f32 v102, v102
  v_exp_f32 v103, v103
  v_max_f32 v56, 0, v56
  v_max_f32 v57, 0, v57
  v_max_f32 v58, 0, v58
  v_max_f32 v59, 0, v59
  v_max_f32 v60, 0, v60
  v_max_f32 v61, 0, v61
  v_max_f32 v62, 0, v62
  v_max_f32 v63, 0, v63
  v_max_f32 v64, 0, v64
  v_max_f32 v65, 0, v65
  v_max_f32 v66, 0, v66
  v_max_f32 v67, 0, v67
  v_max_f32 v68, 0, v68
  v_max_f32 v69, 0, v69
  v_max_f32 v70, 0, v70
  v_max_f32 v71, 0, v71
  v_pk_add_f32 v[56:57], v[56:57], v[88:89]
  v_pk_add_f32 v[58:59], v[58:59], v[90:91]
  v_pk_add_f32 v[60:61], v[60:61], v[92:93]
  v_pk_add_f32 v[62:63], v[62:63], v[94:95]
  v_pk_add_f32 v[64:65], v[64:65], v[96:97]
  v_pk_add_f32 v[66:67], v[66:67], v[98:99]
  v_pk_add_f32 v[68:69], v[68:69], v[100:101]
  v_pk_add_f32 v[70:71], v[70:71], v[102:103]
  v_pk_add_f32 v[56:57], v[56:57], s[70:71]
  v_pk_add_f32 v[58:59], v[58:59], s[70:71]
  v_pk_add_f32 v[60:61], v[60:61], s[70:71]
  v_pk_add_f32 v[62:63], v[62:63], s[70:71]
  v_pk_add_f32 v[64:65], v[64:65], s[70:71]
  v_pk_add_f32 v[66:67], v[66:67], s[70:71]
  v_pk_add_f32 v[68:69], v[68:69], s[70:71]
  v_pk_add_f32 v[70:71], v[70:71], s[70:71]
  v_cvt_pk_bf16_f32 v48, v56, v57
  v_cvt_pk_bf16_f32 v49, v58, v59
  v_cvt_pk_bf16_f32 v50, v60, v61
  v_cvt_pk_bf16_f32 v51, v62, v63
  v_cvt_pk_bf16_f32 v52, v64, v65
  v_cvt_pk_bf16_f32 v53, v66, v67
  v_cvt_pk_bf16_f32 v54, v68, v69
  v_cvt_pk_bf16_f32 v55, v70, v71
  s_barrier
  ds_read_b64_tr_b16 v[88:89], v5 offset:0
  ds_read_b64_tr_b16 v[90:91], v5 offset:512
  ds_read_b64_tr_b16 v[92:93], v5 offset:2048
  ds_read_b64_tr_b16 v[94:95], v5 offset:2560
  s_waitcnt lgkmcnt(2)
  v_mfma_f32_32x32x16_bf16 v[56:71], a[0:3], v[88:91], 0
  ds_read_b64_tr_b16 v[96:97], v5 offset:4096
  ds_read_b64_tr_b16 v[98:99], v5 offset:4608
  v_mfma_f32_16x16x32_bf16 v[112:115], v[28:31], v[88:91], 0
  s_waitcnt lgkmcnt(2)
  v_mfma_f32_32x32x16_bf16 v[56:71], a[4:7], v[92:95], v[56:71]
  ds_read_b64_tr_b16 v[88:89], v5 offset:6144
  ds_read_b64_tr_b16 v[90:91], v5 offset:6656
  v_mfma_f32_16x16x32_bf16 v[112:115], v[28:31], v[92:95], v[112:115]
  s_waitcnt lgkmcnt(2)
  v_mfma_f32_32x32x16_bf16 v[56:71], a[8:11], v[96:99], v[56:71]
  ds_read_b64_tr_b16 v[92:93], v5 offset:8192
  ds_read_b64_tr_b16 v[94:95], v5 offset:8704
  v_mfma_f32_16x16x32_bf16 v[112:115], v[28:31], v[96:99], v[112:115]
  s_waitcnt lgkmcnt(2)
  v_mfma_f32_32x32x16_bf16 v[56:71], a[12:15], v[88:91], v[56:71]
  ds_read_b64_tr_b16 v[96:97], v5 offset:10240
  ds_read_b64_tr_b16 v[98:99], v5 offset:10752
  v_mfma_f32_16x16x32_bf16 v[112:115], v[28:31], v[88:91], v[112:115]
  s_waitcnt lgkmcnt(2)
  v_mfma_f32_32x32x16_bf16 v[56:71], a[16:19], v[92:95], v[56:71]
  ds_read_b64_tr_b16 v[88:89], v5 offset:12288
  ds_read_b64_tr_b16 v[90:91], v5 offset:12800
  v_mfma_f32_16x16x32_bf16 v[112:115], v[28:31], v[92:95], v[112:115]
  s_waitcnt lgkmcnt(2)
  v_mfma_f32_32x32x16_bf16 v[56:71], a[20:23], v[96:99], v[56:71]
  ds_read_b64_tr_b16 v[92:93], v5 offset:14336
  ds_read_b64_tr_b16 v[94:95], v5 offset:14848
  v_mfma_f32_16x16x32_bf16 v[112:115], v[28:31], v[96:99], v[112:115]
  s_waitcnt lgkmcnt(2)
  v_mfma_f32_32x32x16_bf16 v[56:71], a[24:27], v[88:91], v[56:71]
  s_waitcnt lgkmcnt(0)
  s_waitcnt vmcnt(0)
  s_barrier
  s_lshl_b32 s76, s45, 7
  s_lshl_b32 s77, s44, 2
  s_add_u32 s76, s76, s77
  s_add_u32 s76, s76, 12742656
  v_mov_b32 v13, 1
  buffer_store_dword v13, v14, s[36:39], s76 offen sc1
  ds_read_b64_tr_b16 v[96:97], v3 offset:0
  ds_read_b64_tr_b16 v[98:99], v3 offset:512
  v_mfma_f32_16x16x32_bf16 v[112:115], v[28:31], v[88:91], v[112:115]
  v_mfma_f32_32x32x16_bf16 v[56:71], a[28:31], v[92:95], v[56:71]
  ds_read_b64_tr_b16 v[88:89], v3 offset:2048
  ds_read_b64_tr_b16 v[90:91], v3 offset:2560
  v_mfma_f32_16x16x32_bf16 v[112:115], v[28:31], v[92:95], v[112:115]
  s_waitcnt lgkmcnt(2)
  v_mfma_f32_32x32x16_bf16 v[56:71], a[32:35], v[96:99], v[56:71]
  ds_read_b64_tr_b16 v[92:93], v3 offset:4096
  ds_read_b64_tr_b16 v[94:95], v3 offset:4608
  v_mfma_f32_16x16x32_bf16 v[112:115], v[28:31], v[96:99], v[112:115]
  s_waitcnt lgkmcnt(2)
  v_mfma_f32_32x32x16_bf16 v[56:71], a[36:39], v[88:91], v[56:71]
  ds_read_b64_tr_b16 v[96:97], v3 offset:6144
  ds_read_b64_tr_b16 v[98:99], v3 offset:6656
  v_mfma_f32_16x16x32_bf16 v[112:115], v[28:31], v[88:91], v[112:115]
  s_waitcnt lgkmcnt(2)
  v_mfma_f32_32x32x16_bf16 v[56:71], a[40:43], v[92:95], v[56:71]
  ds_read_b64_tr_b16 v[88:89], v3 offset:8192
  ds_read_b64_tr_b16 v[90:91], v3 offset:8704
  v_mfma_f32_16x16x32_bf16 v[112:115], v[28:31], v[92:95], v[112:115]
  s_waitcnt lgkmcnt(2)
  v_mfma_f32_32x32x16_bf16 v[56:71], a[44:47], v[96:99], v[56:71]
  ds_read_b64_tr_b16 v[92:93], v3 offset:10240
  ds_read_b64_tr_b16 v[94:95], v3 offset:10752
  v_mfma_f32_16x16x32_bf16 v[112:115], v[28:31], v[96:99], v[112:115]
  s_waitcnt lgkmcnt(2)
  v_mfma_f32_32x32x16_bf16 v[56:71], a[48:51], v[88:91], v[56:71]
  ds_read_b64_tr_b16 v[96:97], v3 offset:12288
  ds_read_b64_tr_b16 v[98:99], v3 offset:12800
  v_mfma_f32_16x16x32_bf16 v[112:115], v[28:31], v[88:91], v[112:115]
  s_waitcnt lgkmcnt(2)
  v_mfma_f32_32x32x16_bf16 v[56:71], a[52:55], v[92:95], v[56:71]
  ds_read_b64_tr_b16 v[88:89], v3 offset:14336
  ds_read_b64_tr_b16 v[90:91], v3 offset:14848
  v_mfma_f32_16x16x32_bf16 v[112:115], v[28:31], v[92:95], v[112:115]
  s_waitcnt lgkmcnt(2)
  v_mfma_f32_32x32x16_bf16 v[56:71], a[56:59], v[96:99], v[56:71]
  s_waitcnt lgkmcnt(0)
  s_barrier
  ds_read_b64_tr_b16 v[92:93], v3 offset:16384
  ds_read_b64_tr_b16 v[94:95], v3 offset:16896
  v_mfma_f32_16x16x32_bf16 v[112:115], v[28:31], v[96:99], v[112:115]
  v_mfma_f32_32x32x16_bf16 v[56:71], a[60:63], v[88:91], v[56:71]
  ds_read_b64_tr_b16 v[96:97], v3 offset:18432
  ds_read_b64_tr_b16 v[98:99], v3 offset:18944
  v_mfma_f32_16x16x32_bf16 v[112:115], v[28:31], v[88:91], v[112:115]
  s_waitcnt lgkmcnt(2)
  v_mfma_f32_32x32x16_bf16 v[56:71], a[64:67], v[92:95], v[56:71]
  ds_read_b64_tr_b16 v[88:89], v3 offset:20480
  ds_read_b64_tr_b16 v[90:91], v3 offset:20992
  v_mfma_f32_16x16x32_bf16 v[112:115], v[28:31], v[92:95], v[112:115]
  s_waitcnt lgkmcnt(2)
  v_mfma_f32_32x32x16_bf16 v[56:71], a[68:71], v[96:99], v[56:71]
  ds_read_b64_tr_b16 v[92:93], v3 offset:22528
  ds_read_b64_tr_b16 v[94:95], v3 offset:23040
  v_mfma_f32_16x16x32_bf16 v[112:115], v[28:31], v[96:99], v[112:115]
  s_waitcnt lgkmcnt(2)
  v_mfma_f32_32x32x16_bf16 v[56:71], a[72:75], v[88:91], v[56:71]
  ds_read_b64_tr_b16 v[96:97], v3 offset:24576
  ds_read_b64_tr_b16 v[98:99], v3 offset:25088
  v_mfma_f32_16x16x32_bf16 v[112:115], v[28:31], v[88:91], v[112:115]
  s_waitcnt lgkmcnt(2)
  v_mfma_f32_32x32x16_bf16 v[56:71], a[76:79], v[92:95], v[56:71]
  ds_read_b64_tr_b16 v[88:89], v3 offset:26624
  ds_read_b64_tr_b16 v[90:91], v3 offset:27136
  v_mfma_f32_16x16x32_bf16 v[112:115], v[28:31], v[92:95], v[112:115]
  s_waitcnt lgkmcnt(2)
  v_mfma_f32_32x32x16_bf16 v[56:71], a[80:83], v[96:99], v[56:71]
  ds_read_b64_tr_b16 v[92:93], v3 offset:28672
  ds_read_b64_tr_b16 v[94:95], v3 offset:29184
  v_mfma_f32_16x16x32_bf16 v[112:115], v[28:31], v[96:99], v[112:115]
  s_waitcnt lgkmcnt(2)
  v_mfma_f32_32x32x16_bf16 v[56:71], a[84:87], v[88:91], v[56:71]
  ds_read_b64_tr_b16 v[96:97], v3 offset:30720
  ds_read_b64_tr_b16 v[98:99], v3 offset:31232
  v_mfma_f32_16x16x32_bf16 v[112:115], v[28:31], v[88:91], v[112:115]
  s_waitcnt lgkmcnt(2)
  v_mfma_f32_32x32x16_bf16 v[56:71], a[88:91], v[92:95], v[56:71]
  s_waitcnt lgkmcnt(0)
  s_barrier
  ds_read_b64_tr_b16 v[88:89], v3 offset:32768
  ds_read_b64_tr_b16 v[90:91], v3 offset:33280
  v_mfma_f32_16x16x32_bf16 v[112:115], v[28:31], v[92:95], v[112:115]
  v_mfma_f32_32x32x16_bf16 v[56:71], a[92:95], v[96:99], v[56:71]
  ds_read_b64_tr_b16 v[92:93], v3 offset:34816
  ds_read_b64_tr_b16 v[94:95], v3 offset:35328
  v_mfma_f32_16x16x32_bf16 v[112:115], v[28:31], v[96:99], v[112:115]
  s_waitcnt lgkmcnt(2)
  v_mfma_f32_32x32x16_bf16 v[56:71], a[96:99], v[88:91], v[56:71]
  ds_read_b64_tr_b16 v[96:97], v3 offset:36864
  ds_read_b64_tr_b16 v[98:99], v3 offset:37376
  v_mfma_f32_16x16x32_bf16 v[112:115], v[28:31], v[88:91], v[112:115]
  s_waitcnt lgkmcnt(2)
  v_mfma_f32_32x32x16_bf16 v[56:71], a[100:103], v[92:95], v[56:71]
  ds_read_b64_tr_b16 v[88:89], v3 offset:38912
  ds_read_b64_tr_b16 v[90:91], v3 offset:39424
  v_mfma_f32_16x16x32_bf16 v[112:115], v[28:31], v[92:95], v[112:115]
  s_waitcnt lgkmcnt(2)
  v_mfma_f32_32x32x16_bf16 v[56:71], a[104:107], v[96:99], v[56:71]
  ds_read_b64_tr_b16 v[92:93], v3 offset:40960
  ds_read_b64_tr_b16 v[94:95], v3 offset:41472
  v_mfma_f32_16x16x32_bf16 v[112:115], v[28:31], v[96:99], v[112:115]
  s_waitcnt lgkmcnt(2)
  v_mfma_f32_32x32x16_bf16 v[56:71], a[108:111], v[88:91], v[56:71]
  ds_read_b64_tr_b16 v[96:97], v3 offset:43008
  ds_read_b64_tr_b16 v[98:99], v3 offset:43520
  v_mfma_f32_16x16x32_bf16 v[112:115], v[28:31], v[88:91], v[112:115]
  s_waitcnt lgkmcnt(2)
  v_mfma_f32_32x32x16_bf16 v[56:71], a[112:115], v[92:95], v[56:71]
  ds_read_b64_tr_b16 v[88:89], v3 offset:45056
  ds_read_b64_tr_b16 v[90:91], v3 offset:45568
  v_mfma_f32_16x16x32_bf16 v[112:115], v[28:31], v[92:95], v[112:115]
  s_waitcnt lgkmcnt(2)
  v_mfma_f32_32x32x16_bf16 v[56:71], a[116:119], v[96:99], v[56:71]
  ds_read_b64_tr_b16 v[92:93], v3 offset:47104
  ds_read_b64_tr_b16 v[94:95], v3 offset:47616
  v_mfma_f32_16x16x32_bf16 v[112:115], v[28:31], v[96:99], v[112:115]
  s_waitcnt lgkmcnt(2)
  v_mfma_f32_32x32x16_bf16 v[56:71], a[120:123], v[88:91], v[56:71]
  v_mfma_f32_16x16x32_bf16 v[112:115], v[28:31], v[88:91], v[112:115]
  s_waitcnt lgkmcnt(0)
  v_mfma_f32_32x32x16_bf16 v[56:71], a[124:127], v[92:95], v[56:71]
  v_mfma_f32_16x16x32_bf16 v[112:115], v[28:31], v[92:95], v[112:115]
  s_lshl_b32 s58, s46, 8
  s_add_u32 s58, s58, 148480
  v_lshrrev_b32 v13, 5, v1
  v_lshl_add_u32 v13, v13, 4, s58
  s_nop 5
  v_cndmask_b32 v120, v112, v113, s[62:63]
  ds_read_b128 v[104:107], v13 offset:128
  ds_read_b128 v[108:111], v13 offset:160
  ds_read_b128 v[112:115], v13 offset:192
  ds_read_b128 v[116:119], v13 offset:224
  ds_read_b128 v[88:91], v13 offset:0
  ds_read_b128 v[92:95], v13 offset:32
  ds_read_b128 v[96:99], v13 offset:64
  ds_read_b128 v[100:103], v13 offset:96
  s_waitcnt lgkmcnt(0)
  v_pk_fma_f32 v[56:57], v[104:105], v[120:121], v[56:57] op_sel_hi:[1,0,1] neg_lo:[0,1,0] neg_hi:[0,1,0]
  v_pk_fma_f32 v[58:59], v[106:107], v[120:121], v[58:59] op_sel_hi:[1,0,1] neg_lo:[0,1,0] neg_hi:[0,1,0]
  v_pk_fma_f32 v[60:61], v[108:109], v[120:121], v[60:61] op_sel_hi:[1,0,1] neg_lo:[0,1,0] neg_hi:[0,1,0]
  v_pk_fma_f32 v[62:63], v[110:111], v[120:121], v[62:63] op_sel_hi:[1,0,1] neg_lo:[0,1,0] neg_hi:[0,1,0]
  v_pk_fma_f32 v[64:65], v[112:113], v[120:121], v[64:65] op_sel_hi:[1,0,1] neg_lo:[0,1,0] neg_hi:[0,1,0]
  v_pk_fma_f32 v[66:67], v[114:115], v[120:121], v[66:67] op_sel_hi:[1,0,1] neg_lo:[0,1,0] neg_hi:[0,1,0]
  v_pk_fma_f32 v[68:69], v[116:117], v[120:121], v[68:69] op_sel_hi:[1,0,1] neg_lo:[0,1,0] neg_hi:[0,1,0]
  v_pk_fma_f32 v[70:71], v[118:119], v[120:121], v[70:71] op_sel_hi:[1,0,1] neg_lo:[0,1,0] neg_hi:[0,1,0]
  v_pk_mul_f32 v[56:57], v[56:57], v[88:89]
  v_pk_mul_f32 v[58:59], v[58:59], v[90:91]
  v_pk_mul_f32 v[60:61], v[60:61], v[92:93]
  v_pk_mul_f32 v[62:63], v[62:63], v[94:95]
  v_pk_mul_f32 v[64:65], v[64:65], v[96:97]
  v_pk_mul_f32 v[66:67], v[66:67], v[98:99]
  v_pk_mul_f32 v[68:69], v[68:69], v[100:101]
  v_pk_mul_f32 v[70:71], v[70:71], v[102:103]
  v_pk_mul_f32 v[104:105], v[56:57], s[68:69]
  v_pk_mul_f32 v[106:107], v[58:59], s[68:69]
  v_pk_mul_f32 v[108:109], v[60:61], s[68:69]
  v_pk_mul_f32 v[110:111], v[62:63], s[68:69]
  v_pk_mul_f32 v[112:113], v[64:65], s[68:69]
  v_pk_mul_f32 v[114:115], v[66:67], s[68:69]
  v_pk_mul_f32 v[116:117], v[68:69], s[68:69]
  v_pk_mul_f32 v[118:119], v[70:71], s[68:69]
  v_min_f32 v104, 0, v104
  v_min_f32 v105, 0, v105
  v_min_f32 v106, 0, v106
  v_min_f32 v107, 0, v107
  v_min_f32 v108, 0, v108
  v_min_f32 v109, 0, v109
  v_min_f32 v110, 0, v110
  v_min_f32 v111, 0, v111
  v_min_f32 v112, 0, v112
  v_min_f32 v113, 0, v113
  v_min_f32 v114, 0, v114
  v_min_f32 v115, 0, v115
  v_min_f32 v116, 0, v116
  v_min_f32 v117, 0, v117
  v_min_f32 v118, 0, v118
  v_min_f32 v119, 0, v119
  v_exp_f32 v104, v104
  v_exp_f32 v105, v105
  v_exp_f32 v106, v106
  v_exp_f32 v107, v107
  v_exp_f32 v108, v108
  v_exp_f32 v109, v109
  v_exp_f32 v110, v110
  v_exp_f32 v111, v111
  v_exp_f32 v112, v112
  v_exp_f32 v113, v113
  v_exp_f32 v114, v114
  v_exp_f32 v115, v115
  v_exp_f32 v116, v116
  v_exp_f32 v117, v117
  v_exp_f32 v118, v118
  v_exp_f32 v119, v119
  v_max_f32 v56, 0, v56
  v_max_f32 v57, 0, v57
  v_max_f32 v58, 0, v58
  v_max_f32 v59, 0, v59
  v_max_f32 v60, 0, v60
  v_max_f32 v61, 0, v61
  v_max_f32 v62, 0, v62
  v_max_f32 v63, 0, v63
  v_max_f32 v64, 0, v64
  v_max_f32 v65, 0, v65
  v_max_f32 v66, 0, v66
  v_max_f32 v67, 0, v67
  v_max_f32 v68, 0, v68
  v_max_f32 v69, 0, v69
  v_max_f32 v70, 0, v70
  v_max_f32 v71, 0, v71
  v_pk_add_f32 v[56:57], v[56:57], v[104:105]
  v_pk_add_f32 v[58:59], v[58:59], v[106:107]
  v_pk_add_f32 v[60:61], v[60:61], v[108:109]
  v_pk_add_f32 v[62:63], v[62:63], v[110:111]
  v_pk_add_f32 v[64:65], v[64:65], v[112:113]
  v_pk_add_f32 v[66:67], v[66:67], v[114:115]
  v_pk_add_f32 v[68:69], v[68:69], v[116:117]
  v_pk_add_f32 v[70:71], v[70:71], v[118:119]
  v_pk_add_f32 v[56:57], v[56:57], s[70:71]
  v_pk_add_f32 v[58:59], v[58:59], s[70:71]
  v_pk_add_f32 v[60:61], v[60:61], s[70:71]
  v_pk_add_f32 v[62:63], v[62:63], s[70:71]
  v_pk_add_f32 v[64:65], v[64:65], s[70:71]
  v_pk_add_f32 v[66:67], v[66:67], s[70:71]
  v_pk_add_f32 v[68:69], v[68:69], s[70:71]
  v_pk_add_f32 v[70:71], v[70:71], s[70:71]
  v_cvt_pk_bf16_f32 v72, v56, v57
  v_cvt_pk_bf16_f32 v73, v58, v59
  v_cvt_pk_bf16_f32 v74, v60, v61
  v_cvt_pk_bf16_f32 v75, v62, v63
  v_cvt_pk_bf16_f32 v76, v64, v65
  v_cvt_pk_bf16_f32 v77, v66, v67
  v_cvt_pk_bf16_f32 v78, v68, v69
  v_cvt_pk_bf16_f32 v79, v70, v71
  s_barrier
  ds_read_b128 v[100:103], v10 offset:49152
  ds_read_b64_tr_b16 v[88:89], v6 offset:49152
  ds_read_b64_tr_b16 v[90:91], v6 offset:50176
  ds_read_b128 v[104:107], v10 offset:50176
  ds_read_b64_tr_b16 v[92:93], v6 offset:51200
  ds_read_b64_tr_b16 v[94:95], v6 offset:52224
  s_waitcnt lgkmcnt(3)
  v_mfma_f32_32x32x16_bf16 v[56:71], v[88:91], v[100:103], 0
  ds_read_b128 v[108:111], v10 offset:51200
  ds_read_b64_tr_b16 v[96:97], v6 offset:53248
  ds_read_b64_tr_b16 v[98:99], v6 offset:54272
  s_waitcnt lgkmcnt(3)
  v_mfma_f32_32x32x16_bf16 v[56:71], v[92:95], v[104:107], v[56:71]
  ds_read_b128 v[100:103], v10 offset:52224
  ds_read_b64_tr_b16 v[88:89], v6 offset:55296
  ds_read_b64_tr_b16 v[90:91], v6 offset:56320
  s_waitcnt lgkmcnt(3)
  v_mfma_f32_32x32x16_bf16 v[56:71], v[96:99], v[108:111], v[56:71]
  ds_read_b128 v[104:107], v10 offset:53248
  ds_read_b64_tr_b16 v[92:93], v6 offset:57344
  ds_read_b64_tr_b16 v[94:95], v6 offset:58368
  s_waitcnt lgkmcnt(3)
  v_mfma_f32_32x32x16_bf16 v[56:71], v[88:91], v[100:103], v[56:71]
  ds_read_b128 v[108:111], v10 offset:54272
  ds_read_b64_tr_b16 v[96:97], v6 offset:59392
  ds_read_b64_tr_b16 v[98:99], v6 offset:60416
  s_waitcnt lgkmcnt(3)
  v_mfma_f32_32x32x16_bf16 v[56:71], v[92:95], v[104:107], v[56:71]
  ds_read_b128 v[100:103], v10 offset:55296
  ds_read_b64_tr_b16 v[88:89], v6 offset:61440
  ds_read_b64_tr_b16 v[90:91], v6 offset:62464
  s_waitcnt lgkmcnt(3)
  v_mfma_f32_32x32x16_bf16 v[56:71], v[96:99], v[108:111], v[56:71]
  ds_read_b128 v[104:107], v10 offset:56320
  ds_read_b64_tr_b16 v[92:93], v6 offset:63488
  ds_read_b64_tr_b16 v[94:95], v6 offset:64512
  s_waitcnt lgkmcnt(3)
  v_mfma_f32_32x32x16_bf16 v[56:71], v[88:91], v[100:103], v[56:71]
  s_waitcnt lgkmcnt(0)
  s_barrier
  ds_read_b128 v[108:111], v11 offset:0
  ds_read_b64_tr_b16 v[96:97], v7 offset:0
  ds_read_b64_tr_b16 v[98:99], v7 offset:1024
  v_mfma_f32_32x32x16_bf16 v[56:71], v[92:95], v[104:107], v[56:71]
  ds_read_b128 v[100:103], v11 offset:1024
  ds_read_b64_tr_b16 v[88:89], v7 offset:2048
  ds_read_b64_tr_b16 v[90:91], v7 offset:3072
  s_waitcnt lgkmcnt(3)
  v_mfma_f32_32x32x16_bf16 v[56:71], v[96:99], v[108:111], v[56:71]
  ds_read_b128 v[104:107], v11 offset:2048
  ds_read_b64_tr_b16 v[92:93], v7 offset:4096
  ds_read_b64_tr_b16 v[94:95], v7 offset:5120
  s_waitcnt lgkmcnt(3)
  v_mfma_f32_32x32x16_bf16 v[56:71], v[88:91], v[100:103], v[56:71]
  ds_read_b128 v[108:111], v11 offset:3072
  ds_read_b64_tr_b16 v[96:97], v7 offset:6144
  ds_read_b64_tr_b16 v[98:99], v7 offset:7168
  s_waitcnt lgkmcnt(3)
  v_mfma_f32_32x32x16_bf16 v[56:71], v[92:95], v[104:107], v[56:71]
  ds_read_b128 v[100:103], v11 offset:4096
  ds_read_b64_tr_b16 v[88:89], v7 offset:8192
  ds_read_b64_tr_b16 v[90:91], v7 offset:9216
  s_waitcnt lgkmcnt(3)
  v_mfma_f32_32x32x16_bf16 v[56:71], v[96:99], v[108:111], v[56:71]
  ds_read_b128 v[104:107], v11 offset:5120
  ds_read_b64_tr_b16 v[92:93], v7 offset:10240
  ds_read_b64_tr_b16 v[94:95], v7 offset:11264
  s_waitcnt lgkmcnt(3)
  v_mfma_f32_32x32x16_bf16 v[56:71], v[88:91], v[100:103], v[56:71]
  ds_read_b128 v[108:111], v11 offset:6144
  ds_read_b64_tr_b16 v[96:97], v7 offset:12288
  ds_read_b64_tr_b16 v[98:99], v7 offset:13312
  s_waitcnt lgkmcnt(3)
  v_mfma_f32_32x32x16_bf16 v[56:71], v[92:95], v[104:107], v[56:71]
  ds_read_b128 v[100:103], v11 offset:7168
  ds_read_b64_tr_b16 v[88:89], v7 offset:14336
  ds_read_b64_tr_b16 v[90:91], v7 offset:15360
  s_waitcnt lgkmcnt(3)
  v_mfma_f32_32x32x16_bf16 v[56:71], v[96:99], v[108:111], v[56:71]
  s_waitcnt lgkmcnt(0)
  s_barrier
  ds_read_b128 v[104:107], v9 offset:0
  ds_read_b64_tr_b16 v[92:93], v7 offset:16384
  ds_read_b64_tr_b16 v[94:95], v7 offset:17408
  v_mfma_f32_32x32x16_bf16 v[56:71], v[88:91], v[100:103], v[56:71]
  ds_read_b128 v[108:111], v9 offset:1024
  ds_read_b64_tr_b16 v[96:97], v7 offset:18432
  ds_read_b64_tr_b16 v[98:99], v7 offset:19456
  s_waitcnt lgkmcnt(3)
  v_mfma_f32_32x32x16_bf16 v[56:71], v[92:95], v[104:107], v[56:71]
  ds_read_b128 v[100:103], v9 offset:2048
  ds_read_b64_tr_b16 v[88:89], v7 offset:20480
  ds_read_b64_tr_b16 v[90:91], v7 offset:21504
  s_waitcnt lgkmcnt(3)
  v_mfma_f32_32x32x16_bf16 v[56:71], v[96:99], v[108:111], v[56:71]
  ds_read_b128 v[104:107], v9 offset:3072
  ds_read_b64_tr_b16 v[92:93], v7 offset:22528
  ds_read_b64_tr_b16 v[94:95], v7 offset:23552
  s_waitcnt lgkmcnt(3)
  v_mfma_f32_32x32x16_bf16 v[56:71], v[88:91], v[100:103], v[56:71]
  ds_read_b128 v[108:111], v9 offset:4096
  ds_read_b64_tr_b16 v[96:97], v7 offset:24576
  ds_read_b64_tr_b16 v[98:99], v7 offset:25600
  s_waitcnt lgkmcnt(3)
  v_mfma_f32_32x32x16_bf16 v[56:71], v[92:95], v[104:107], v[56:71]
  ds_read_b128 v[100:103], v9 offset:5120
  ds_read_b64_tr_b16 v[88:89], v7 offset:26624
  ds_read_b64_tr_b16 v[90:91], v7 offset:27648
  s_waitcnt lgkmcnt(3)
  v_mfma_f32_32x32x16_bf16 v[56:71], v[96:99], v[108:111], v[56:71]
  ds_read_b128 v[104:107], v9 offset:6144
  ds_read_b64_tr_b16 v[92:93], v7 offset:28672
  ds_read_b64_tr_b16 v[94:95], v7 offset:29696
  s_waitcnt lgkmcnt(3)
  v_mfma_f32_32x32x16_bf16 v[56:71], v[88:91], v[100:103], v[56:71]
  ds_read_b128 v[108:111], v9 offset:7168
  ds_read_b64_tr_b16 v[96:97], v7 offset:30720
  ds_read_b64_tr_b16 v[98:99], v7 offset:31744
  s_waitcnt lgkmcnt(3)
  v_mfma_f32_32x32x16_bf16 v[56:71], v[92:95], v[104:107], v[56:71]
  s_waitcnt lgkmcnt(0)
  s_barrier
  ds_read_b128 v[100:103], v9 offset:16384
  ds_read_b64_tr_b16 v[88:89], v7 offset:32768
  ds_read_b64_tr_b16 v[90:91], v7 offset:33792
  v_mfma_f32_32x32x16_bf16 v[56:71], v[96:99], v[108:111], v[56:71]
  ds_read_b128 v[104:107], v9 offset:17408
  ds_read_b64_tr_b16 v[92:93], v7 offset:34816
  ds_read_b64_tr_b16 v[94:95], v7 offset:35840
  s_waitcnt lgkmcnt(3)
  v_mfma_f32_32x32x16_bf16 v[56:71], v[88:91], v[100:103], v[56:71]
  ds_read_b128 v[108:111], v9 offset:18432
  ds_read_b64_tr_b16 v[96:97], v7 offset:36864
  ds_read_b64_tr_b16 v[98:99], v7 offset:37888
  s_waitcnt lgkmcnt(3)
  v_mfma_f32_32x32x16_bf16 v[56:71], v[92:95], v[104:107], v[56:71]
  ds_read_b128 v[100:103], v9 offset:19456
  ds_read_b64_tr_b16 v[88:89], v7 offset:38912
  ds_read_b64_tr_b16 v[90:91], v7 offset:39936
  s_waitcnt lgkmcnt(3)
  v_mfma_f32_32x32x16_bf16 v[56:71], v[96:99], v[108:111], v[56:71]
  ds_read_b128 v[104:107], v9 offset:20480
  ds_read_b64_tr_b16 v[92:93], v7 offset:40960
  ds_read_b64_tr_b16 v[94:95], v7 offset:41984
  s_waitcnt lgkmcnt(3)
  v_mfma_f32_32x32x16_bf16 v[56:71], v[88:91], v[100:103], v[56:71]
  ds_read_b128 v[108:111], v9 offset:21504
  ds_read_b64_tr_b16 v[96:97], v7 offset:43008
  ds_read_b64_tr_b16 v[98:99], v7 offset:44032
  s_waitcnt lgkmcnt(3)
  v_mfma_f32_32x32x16_bf16 v[56:71], v[92:95], v[104:107], v[56:71]
  ds_read_b128 v[100:103], v9 offset:22528
  ds_read_b64_tr_b16 v[88:89], v7 offset:45056
  ds_read_b64_tr_b16 v[90:91], v7 offset:46080
  s_waitcnt lgkmcnt(3)
  v_mfma_f32_32x32x16_bf16 v[56:71], v[96:99], v[108:111], v[56:71]
  ds_read_b128 v[104:107], v9 offset:23552
  ds_read_b64_tr_b16 v[92:93], v7 offset:47104
  ds_read_b64_tr_b16 v[94:95], v7 offset:48128
  s_waitcnt lgkmcnt(3)
  v_mfma_f32_32x32x16_bf16 v[56:71], v[88:91], v[100:103], v[56:71]
  s_waitcnt lgkmcnt(0)
  v_mfma_f32_32x32x16_bf16 v[56:71], v[92:95], v[104:107], v[56:71]
  s_barrier
  v_lshlrev_b32 v88, 16, v32
  v_and_b32 v89, s75, v32
  v_lshlrev_b32 v90, 16, v33
  v_and_b32 v91, s75, v33
  v_lshlrev_b32 v92, 16, v34
  v_and_b32 v93, s75, v34
  v_lshlrev_b32 v94, 16, v35
  v_and_b32 v95, s75, v35
  v_lshlrev_b32 v96, 16, v36
  v_and_b32 v97, s75, v36
  v_lshlrev_b32 v98, 16, v37
  v_and_b32 v99, s75, v37
  v_lshlrev_b32 v100, 16, v38
  v_and_b32 v101, s75, v38
  v_lshlrev_b32 v102, 16, v39
  v_and_b32 v103, s75, v39
  v_pk_fma_f32 v[56:57], v[88:89], v[20:21], v[56:57] op_sel_hi:[1,0,1]
  v_pk_fma_f32 v[58:59], v[90:91], v[20:21], v[58:59] op_sel_hi:[1,0,1]
  v_pk_fma_f32 v[60:61], v[92:93], v[20:21], v[60:61] op_sel_hi:[1,0,1]
  v_pk_fma_f32 v[62:63], v[94:95], v[20:21], v[62:63] op_sel_hi:[1,0,1]
  v_pk_fma_f32 v[64:65], v[96:97], v[20:21], v[64:65] op_sel_hi:[1,0,1]
  v_pk_fma_f32 v[66:67], v[98:99], v[20:21], v[66:67] op_sel_hi:[1,0,1]
  v_pk_fma_f32 v[68:69], v[100:101], v[20:21], v[68:69] op_sel_hi:[1,0,1]
  v_pk_fma_f32 v[70:71], v[102:103], v[20:21], v[70:71] op_sel_hi:[1,0,1]
  v_pk_add_f32 v[56:57], v[56:57], v[24:25] op_sel_hi:[1,0] neg_lo:[0,1] neg_hi:[0,1]
  v_pk_add_f32 v[58:59], v[58:59], v[24:25] op_sel_hi:[1,0] neg_lo:[0,1] neg_hi:[0,1]
  v_pk_add_f32 v[60:61], v[60:61], v[24:25] op_sel_hi:[1,0] neg_lo:[0,1] neg_hi:[0,1]
  v_pk_add_f32 v[62:63], v[62:63], v[24:25] op_sel_hi:[1,0] neg_lo:[0,1] neg_hi:[0,1]
  v_pk_add_f32 v[64:65], v[64:65], v[24:25] op_sel_hi:[1,0] neg_lo:[0,1] neg_hi:[0,1]
  v_pk_add_f32 v[66:67], v[66:67], v[24:25] op_sel_hi:[1,0] neg_lo:[0,1] neg_hi:[0,1]
  v_pk_add_f32 v[68:69], v[68:69], v[24:25] op_sel_hi:[1,0] neg_lo:[0,1] neg_hi:[0,1]
  v_pk_add_f32 v[70:71], v[70:71], v[24:25] op_sel_hi:[1,0] neg_lo:[0,1] neg_hi:[0,1]
  v_cvt_pk_bf16_f32 v40, v56, v57
  v_cvt_pk_bf16_f32 v41, v58, v59
  v_cvt_pk_bf16_f32 v42, v60, v61
  v_cvt_pk_bf16_f32 v43, v62, v63
  v_cvt_pk_bf16_f32 v44, v64, v65
  v_cvt_pk_bf16_f32 v45, v66, v67
  v_cvt_pk_bf16_f32 v46, v68, v69
  v_cvt_pk_bf16_f32 v47, v70, v71
  s_mul_i32 s58, s60, 32768
  s_mul_i32 s59, s45, 4096
  s_add_u32 s58, s58, s59
  s_lshl_b32 s59, s48, 11
  s_add_u32 s58, s58, s59
  s_add_u32 s58, s58, 2097152
  buffer_store_dwordx4 v[40:43], v2, s[36:39], s58 offen sc1
  buffer_store_dwordx4 v[44:47], v2, s[36:39], s58 offen offset:1024 sc1
  v_mov_b32 v120, 0
  v_mov_b32 v121, 0
  v_dot2c_f32_bf16 v120, s61, v40
  v_dot2c_f32_bf16 v121, v40, v40
  v_dot2c_f32_bf16 v120, s61, v41
  v_dot2c_f32_bf16 v121, v41, v41
  v_dot2c_f32_bf16 v120, s61, v42
  v_dot2c_f32_bf16 v121, v42, v42
  v_dot2c_f32_bf16 v120, s61, v43
  v_dot2c_f32_bf16 v121, v43, v43
  v_dot2c_f32_bf16 v120, s61, v44
  v_dot2c_f32_bf16 v121, v44, v44
  v_dot2c_f32_bf16 v120, s61, v45
  v_dot2c_f32_bf16 v121, v45, v45
  v_dot2c_f32_bf16 v120, s61, v46
  v_dot2c_f32_bf16 v121, v46, v46
  v_dot2c_f32_bf16 v120, s61, v47
  v_dot2c_f32_bf16 v121, v47, v47
  s_lshl_b32 s58, s60, 12
  s_lshl_b32 s59, s45, 9
  s_add_u32 s58, s58, s59
  s_lshl_b32 s59, s48, 8
  s_add_u32 s58, s58, s59
  s_add_u32 s58, s58, 12845056
  v_mov_b32 v122, v120
  v_mov_b32 v123, v121
  s_nop 1
  v_permlane32_swap_b32 v120, v122
  v_permlane32_swap_b32 v121, v123
  s_nop 0
  v_add_f32 v120, v120, v122
  v_add_f32 v121, v121, v123
  buffer_store_dwordx2 v[120:121], v16, s[36:39], s58 offen sc1
  s_barrier
  ds_read_b64_tr_b16 v[88:89], v3 offset:32768
  ds_read_b64_tr_b16 v[90:91], v3 offset:33280
  ds_read_b64_tr_b16 v[92:93], v3 offset:34816
  ds_read_b64_tr_b16 v[94:95], v3 offset:35328
  s_waitcnt lgkmcnt(2)
  v_mfma_f32_32x32x16_bf16 v[56:71], a[0:3], v[88:91], 0
  ds_read_b64_tr_b16 v[96:97], v3 offset:36864
  ds_read_b64_tr_b16 v[98:99], v3 offset:37376
  v_mfma_f32_16x16x32_bf16 v[112:115], v[28:31], v[88:91], 0
  s_waitcnt lgkmcnt(2)
  v_mfma_f32_32x32x16_bf16 v[56:71], a[4:7], v[92:95], v[56:71]
  ds_read_b64_tr_b16 v[88:89], v3 offset:38912
  ds_read_b64_tr_b16 v[90:91], v3 offset:39424
  v_mfma_f32_16x16x32_bf16 v[112:115], v[28:31], v[92:95], v[112:115]
  s_waitcnt lgkmcnt(2)
  v_mfma_f32_32x32x16_bf16 v[56:71], a[8:11], v[96:99], v[56:71]
  ds_read_b64_tr_b16 v[92:93], v3 offset:40960
  ds_read_b64_tr_b16 v[94:95], v3 offset:41472
  v_mfma_f32_16x16x32_bf16 v[112:115], v[28:31], v[96:99], v[112:115]
  s_waitcnt lgkmcnt(2)
  v_mfma_f32_32x32x16_bf16 v[56:71], a[12:15], v[88:91], v[56:71]
  ds_read_b64_tr_b16 v[96:97], v3 offset:43008
  ds_read_b64_tr_b16 v[98:99], v3 offset:43520
  v_mfma_f32_16x16x32_bf16 v[112:115], v[28:31], v[88:91], v[112:115]
  s_waitcnt lgkmcnt(2)
  v_mfma_f32_32x32x16_bf16 v[56:71], a[16:19], v[92:95], v[56:71]
  ds_read_b64_tr_b16 v[88:89], v3 offset:45056
  ds_read_b64_tr_b16 v[90:91], v3 offset:45568
  v_mfma_f32_16x16x32_bf16 v[112:115], v[28:31], v[92:95], v[112:115]
  s_waitcnt lgkmcnt(2)
  v_mfma_f32_32x32x16_bf16 v[56:71], a[20:23], v[96:99], v[56:71]
  ds_read_b64_tr_b16 v[92:93], v3 offset:47104
  ds_read_b64_tr_b16 v[94:95], v3 offset:47616
  v_mfma_f32_16x16x32_bf16 v[112:115], v[28:31], v[96:99], v[112:115]
  s_waitcnt lgkmcnt(2)
  v_mfma_f32_32x32x16_bf16 v[56:71], a[24:27], v[88:91], v[56:71]
  s_waitcnt lgkmcnt(0)
  s_waitcnt vmcnt(0)
  s_barrier
  s_lshl_b32 s76, s44, 7
  s_lshl_b32 s77, s45, 2
  s_add_u32 s76, s76, s77
  s_add_u32 s76, s76, 12718080
  v_mov_b32 v13, 1
  buffer_store_dword v13, v14, s[36:39], s76 offen sc1
  ds_read_b64_tr_b16 v[96:97], v3 offset:49152
  ds_read_b64_tr_b16 v[98:99], v3 offset:49664
  v_mfma_f32_16x16x32_bf16 v[112:115], v[28:31], v[88:91], v[112:115]
  v_mfma_f32_32x32x16_bf16 v[56:71], a[28:31], v[92:95], v[56:71]
  ds_read_b64_tr_b16 v[88:89], v3 offset:51200
  ds_read_b64_tr_b16 v[90:91], v3 offset:51712
  v_mfma_f32_16x16x32_bf16 v[112:115], v[28:31], v[92:95], v[112:115]
  s_waitcnt lgkmcnt(2)
  v_mfma_f32_32x32x16_bf16 v[56:71], a[32:35], v[96:99], v[56:71]
  ds_read_b64_tr_b16 v[92:93], v3 offset:53248
  ds_read_b64_tr_b16 v[94:95], v3 offset:53760
  v_mfma_f32_16x16x32_bf16 v[112:115], v[28:31], v[96:99], v[112:115]
  s_waitcnt lgkmcnt(2)
  v_mfma_f32_32x32x16_bf16 v[56:71], a[36:39], v[88:91], v[56:71]
  ds_read_b64_tr_b16 v[96:97], v3 offset:55296
  ds_read_b64_tr_b16 v[98:99], v3 offset:55808
  v_mfma_f32_16x16x32_bf16 v[112:115], v[28:31], v[88:91], v[112:115]
  s_waitcnt lgkmcnt(2)
  v_mfma_f32_32x32x16_bf16 v[56:71], a[40:43], v[92:95], v[56:71]
  ds_read_b64_tr_b16 v[88:89], v3 offset:57344
  ds_read_b64_tr_b16 v[90:91], v3 offset:57856
  v_mfma_f32_16x16x32_bf16 v[112:115], v[28:31], v[92:95], v[112:115]
  s_waitcnt lgkmcnt(2)
  v_mfma_f32_32x32x16_bf16 v[56:71], a[44:47], v[96:99], v[56:71]
  ds_read_b64_tr_b16 v[92:93], v3 offset:59392
  ds_read_b64_tr_b16 v[94:95], v3 offset:59904
  v_mfma_f32_16x16x32_bf16 v[112:115], v[28:31], v[96:99], v[112:115]
  s_waitcnt lgkmcnt(2)
  v_mfma_f32_32x32x16_bf16 v[56:71], a[48:51], v[88:91], v[56:71]
  ds_read_b64_tr_b16 v[96:97], v3 offset:61440
  ds_read_b64_tr_b16 v[98:99], v3 offset:61952
  v_mfma_f32_16x16x32_bf16 v[112:115], v[28:31], v[88:91], v[112:115]
  s_waitcnt lgkmcnt(2)
  v_mfma_f32_32x32x16_bf16 v[56:71], a[52:55], v[92:95], v[56:71]
  ds_read_b64_tr_b16 v[88:89], v3 offset:63488
  ds_read_b64_tr_b16 v[90:91], v3 offset:64000
  v_mfma_f32_16x16x32_bf16 v[112:115], v[28:31], v[92:95], v[112:115]
  s_waitcnt lgkmcnt(2)
  v_mfma_f32_32x32x16_bf16 v[56:71], a[56:59], v[96:99], v[56:71]
  s_waitcnt lgkmcnt(0)
  s_barrier
  ds_read_b64_tr_b16 v[92:93], v4 offset:49152
  ds_read_b64_tr_b16 v[94:95], v4 offset:49664
  v_mfma_f32_16x16x32_bf16 v[112:115], v[28:31], v[96:99], v[112:115]
  v_mfma_f32_32x32x16_bf16 v[56:71], a[60:63], v[88:91], v[56:71]
  ds_read_b64_tr_b16 v[96:97], v4 offset:51200
  ds_read_b64_tr_b16 v[98:99], v4 offset:51712
  v_mfma_f32_16x16x32_bf16 v[112:115], v[28:31], v[88:91], v[112:115]
  s_waitcnt lgkmcnt(2)
  v_mfma_f32_32x32x16_bf16 v[56:71], a[64:67], v[92:95], v[56:71]
  ds_read_b64_tr_b16 v[88:89], v4 offset:53248
  ds_read_b64_tr_b16 v[90:91], v4 offset:53760
  v_mfma_f32_16x16x32_bf16 v[112:115], v[28:31], v[92:95], v[112:115]
  s_waitcnt lgkmcnt(2)
  v_mfma_f32_32x32x16_bf16 v[56:71], a[68:71], v[96:99], v[56:71]
  ds_read_b64_tr_b16 v[92:93], v4 offset:55296
  ds_read_b64_tr_b16 v[94:95], v4 offset:55808
  v_mfma_f32_16x16x32_bf16 v[112:115], v[28:31], v[96:99], v[112:115]
  s_waitcnt lgkmcnt(2)
  v_mfma_f32_32x32x16_bf16 v[56:71], a[72:75], v[88:91], v[56:71]
  ds_read_b64_tr_b16 v[96:97], v4 offset:57344
  ds_read_b64_tr_b16 v[98:99], v4 offset:57856
  v_mfma_f32_16x16x32_bf16 v[112:115], v[28:31], v[88:91], v[112:115]
  s_waitcnt lgkmcnt(2)
  v_mfma_f32_32x32x16_bf16 v[56:71], a[76:79], v[92:95], v[56:71]
  ds_read_b64_tr_b16 v[88:89], v4 offset:59392
  ds_read_b64_tr_b16 v[90:91], v4 offset:59904
  v_mfma_f32_16x16x32_bf16 v[112:115], v[28:31], v[92:95], v[112:115]
  s_waitcnt lgkmcnt(2)
  v_mfma_f32_32x32x16_bf16 v[56:71], a[80:83], v[96:99], v[56:71]
  ds_read_b64_tr_b16 v[92:93], v4 offset:61440
  ds_read_b64_tr_b16 v[94:95], v4 offset:61952
  v_mfma_f32_16x16x32_bf16 v[112:115], v[28:31], v[96:99], v[112:115]
  s_waitcnt lgkmcnt(2)
  v_mfma_f32_32x32x16_bf16 v[56:71], a[84:87], v[88:91], v[56:71]
  ds_read_b64_tr_b16 v[96:97], v4 offset:63488
  ds_read_b64_tr_b16 v[98:99], v4 offset:64000
  v_mfma_f32_16x16x32_bf16 v[112:115], v[28:31], v[88:91], v[112:115]
  s_waitcnt lgkmcnt(2)
  v_mfma_f32_32x32x16_bf16 v[56:71], a[88:91], v[92:95], v[56:71]
  s_waitcnt lgkmcnt(0)
  s_barrier
  ds_read_b64_tr_b16 v[88:89], v4 offset:0
  ds_read_b64_tr_b16 v[90:91], v4 offset:512
  v_mfma_f32_16x16x32_bf16 v[112:115], v[28:31], v[92:95], v[112:115]
  v_mfma_f32_32x32x16_bf16 v[56:71], a[92:95], v[96:99], v[56:71]
  ds_read_b64_tr_b16 v[92:93], v4 offset:2048
  ds_read_b64_tr_b16 v[94:95], v4 offset:2560
  v_mfma_f32_16x16x32_bf16 v[112:115], v[28:31], v[96:99], v[112:115]
  s_waitcnt lgkmcnt(2)
  v_mfma_f32_32x32x16_bf16 v[56:71], a[96:99], v[88:91], v[56:71]
  ds_read_b64_tr_b16 v[96:97], v4 offset:4096
  ds_read_b64_tr_b16 v[98:99], v4 offset:4608
  v_mfma_f32_16x16x32_bf16 v[112:115], v[28:31], v[88:91], v[112:115]
  s_waitcnt lgkmcnt(2)
  v_mfma_f32_32x32x16_bf16 v[56:71], a[100:103], v[92:95], v[56:71]
  ds_read_b64_tr_b16 v[88:89], v4 offset:6144
  ds_read_b64_tr_b16 v[90:91], v4 offset:6656
  v_mfma_f32_16x16x32_bf16 v[112:115], v[28:31], v[92:95], v[112:115]
  s_waitcnt lgkmcnt(2)
  v_mfma_f32_32x32x16_bf16 v[56:71], a[104:107], v[96:99], v[56:71]
  ds_read_b64_tr_b16 v[92:93], v4 offset:8192
  ds_read_b64_tr_b16 v[94:95], v4 offset:8704
  v_mfma_f32_16x16x32_bf16 v[112:115], v[28:31], v[96:99], v[112:115]
  s_waitcnt lgkmcnt(2)
  v_mfma_f32_32x32x16_bf16 v[56:71], a[108:111], v[88:91], v[56:71]
  ds_read_b64_tr_b16 v[96:97], v4 offset:10240
  ds_read_b64_tr_b16 v[98:99], v4 offset:10752
  v_mfma_f32_16x16x32_bf16 v[112:115], v[28:31], v[88:91], v[112:115]
  s_waitcnt lgkmcnt(2)
  v_mfma_f32_32x32x16_bf16 v[56:71], a[112:115], v[92:95], v[56:71]
  ds_read_b64_tr_b16 v[88:89], v4 offset:12288
  ds_read_b64_tr_b16 v[90:91], v4 offset:12800
  v_mfma_f32_16x16x32_bf16 v[112:115], v[28:31], v[92:95], v[112:115]
  s_waitcnt lgkmcnt(2)
  v_mfma_f32_32x32x16_bf16 v[56:71], a[116:119], v[96:99], v[56:71]
  ds_read_b64_tr_b16 v[92:93], v4 offset:14336
  ds_read_b64_tr_b16 v[94:95], v4 offset:14848
  v_mfma_f32_16x16x32_bf16 v[112:115], v[28:31], v[96:99], v[112:115]
  s_waitcnt lgkmcnt(2)
  v_mfma_f32_32x32x16_bf16 v[56:71], a[120:123], v[88:91], v[56:71]
  v_mfma_f32_16x16x32_bf16 v[112:115], v[28:31], v[88:91], v[112:115]
  s_waitcnt lgkmcnt(0)
  v_mfma_f32_32x32x16_bf16 v[56:71], a[124:127], v[92:95], v[56:71]
  v_mfma_f32_16x16x32_bf16 v[112:115], v[28:31], v[92:95], v[112:115]
  s_barrier
  s_lshl_b32 s58, s46, 8
  s_add_u32 s58, s58, 148480
  v_lshrrev_b32 v13, 5, v1
  v_lshl_add_u32 v13, v13, 4, s58
  s_nop 5
  v_cndmask_b32 v120, v112, v113, s[62:63]
  ds_read_b128 v[104:107], v13 offset:128
  ds_read_b128 v[108:111], v13 offset:160
  ds_read_b128 v[112:115], v13 offset:192
  ds_read_b128 v[116:119], v13 offset:224
  ds_read_b128 v[88:91], v13 offset:0
  ds_read_b128 v[92:95], v13 offset:32
  ds_read_b128 v[96:99], v13 offset:64
  ds_read_b128 v[100:103], v13 offset:96
  s_waitcnt lgkmcnt(0)
  v_pk_fma_f32 v[56:57], v[104:105], v[120:121], v[56:57] op_sel_hi:[1,0,1] neg_lo:[0,1,0] neg_hi:[0,1,0]
  v_pk_fma_f32 v[58:59], v[106:107], v[120:121], v[58:59] op_sel_hi:[1,0,1] neg_lo:[0,1,0] neg_hi:[0,1,0]
  v_pk_fma_f32 v[60:61], v[108:109], v[120:121], v[60:61] op_sel_hi:[1,0,1] neg_lo:[0,1,0] neg_hi:[0,1,0]
  v_pk_fma_f32 v[62:63], v[110:111], v[120:121], v[62:63] op_sel_hi:[1,0,1] neg_lo:[0,1,0] neg_hi:[0,1,0]
  v_pk_fma_f32 v[64:65], v[112:113], v[120:121], v[64:65] op_sel_hi:[1,0,1] neg_lo:[0,1,0] neg_hi:[0,1,0]
  v_pk_fma_f32 v[66:67], v[114:115], v[120:121], v[66:67] op_sel_hi:[1,0,1] neg_lo:[0,1,0] neg_hi:[0,1,0]
  v_pk_fma_f32 v[68:69], v[116:117], v[120:121], v[68:69] op_sel_hi:[1,0,1] neg_lo:[0,1,0] neg_hi:[0,1,0]
  v_pk_fma_f32 v[70:71], v[118:119], v[120:121], v[70:71] op_sel_hi:[1,0,1] neg_lo:[0,1,0] neg_hi:[0,1,0]
  v_pk_mul_f32 v[56:57], v[56:57], v[88:89]
  v_pk_mul_f32 v[58:59], v[58:59], v[90:91]
  v_pk_mul_f32 v[60:61], v[60:61], v[92:93]
  v_pk_mul_f32 v[62:63], v[62:63], v[94:95]
  v_pk_mul_f32 v[64:65], v[64:65], v[96:97]
  v_pk_mul_f32 v[66:67], v[66:67], v[98:99]
  v_pk_mul_f32 v[68:69], v[68:69], v[100:101]
  v_pk_mul_f32 v[70:71], v[70:71], v[102:103]
  v_cvt_pk_bf16_f32 v56, v56, v57
  v_cvt_pk_bf16_f32 v57, v58, v59
  v_cvt_pk_bf16_f32 v58, v60, v61
  v_cvt_pk_bf16_f32 v59, v62, v63
  v_cvt_pk_bf16_f32 v60, v64, v65
  v_cvt_pk_bf16_f32 v61, v66, v67
  v_cvt_pk_bf16_f32 v62, v68, v69
  v_cvt_pk_bf16_f32 v63, v70, v71
  v_mov_b32 v80, 0
  s_nop 0
  v_mfma_f32_32x32x16_bf16 v[88:103], v[72:75], v[56:59], 0
  v_mfma_f32_32x32x16_bf16 v[88:103], v[76:79], v[60:63], v[88:103]
  s_mul_i32 s58, s48, 2304
  s_add_u32 s58, s58, 149504
  s_xor_b32 s59, s47, 1
  s_lshl_b32 s59, s59, 18
  s_add_u32 s58, s58, s59
  v_add_u32 v81, s58, v2
  v_lshl_add_u32 v82, v1, 2, s58
  s_nop 9
  v_dot2c_f32_bf16 v80, s61, v72
  v_dot2c_f32_bf16 v80, s61, v73
  v_dot2c_f32_bf16 v80, s61, v74
  v_dot2c_f32_bf16 v80, s61, v75
  v_dot2c_f32_bf16 v80, s61, v76
  v_dot2c_f32_bf16 v80, s61, v77
  v_dot2c_f32_bf16 v80, s61, v78
  v_dot2c_f32_bf16 v80, s61, v79
  v_cndmask_b32 v72, v88, v96, s[62:63]
  v_cndmask_b32 v73, v89, v97, s[62:63]
  v_cndmask_b32 v74, v90, v98, s[62:63]
  v_cndmask_b32 v75, v91, v99, s[62:63]
  v_cndmask_b32 v76, v92, v100, s[62:63]
  v_cndmask_b32 v77, v93, v101, s[62:63]
  v_cndmask_b32 v78, v94, v102, s[62:63]
  v_cndmask_b32 v79, v95, v103, s[62:63]
  ds_write_b128 v81, v[72:75]
  ds_write_b128 v81, v[76:79] offset:1024
  ds_write_b32 v82, v80 offset:2048
  s_waitcnt lgkmcnt(0)
  s_barrier
  ds_read_b128 a[0:3], v11 offset:0
  ds_read_b64_tr_b16 v[88:89], v7 offset:16384
  ds_read_b64_tr_b16 v[90:91], v7 offset:17408
  ds_read_b128 a[4:7], v11 offset:1024
  ds_read_b64_tr_b16 v[92:93], v7 offset:18432
  ds_read_b64_tr_b16 v[94:95], v7 offset:19456
  s_waitcnt lgkmcnt(3)
  v_mfma_f32_32x32x16_bf16 v[56:71], v[88:91], a[0:3], 0
  ds_read_b128 a[8:11], v11 offset:2048
  ds_read_b64_tr_b16 v[96:97], v7 offset:20480
  ds_read_b64_tr_b16 v[98:99], v7 offset:21504
  v_mfma_f32_16x16x32_bf16 v[112:115], v[28:31], v[88:91], 0
  s_mul_i32 s58, s48, 2304
  s_add_u32 s58, s58, 149504
  v_add_u32 v81, s58, v2
  v_lshl_add_u32 v82, v1, 2, s58
  ds_read_b128 v[100:103], v81
  ds_read_b128 v[104:107], v81 offset:1024
  ds_read_b32 v108, v82 offset:2048
  s_waitcnt lgkmcnt(6)
  v_mfma_f32_32x32x16_bf16 v[56:71], v[92:95], a[4:7], v[56:71]
  ds_read_b128 a[12:15], v11 offset:3072
  ds_read_b64_tr_b16 v[88:89], v7 offset:22528
  ds_read_b64_tr_b16 v[90:91], v7 offset:23552
  v_mfma_f32_16x16x32_bf16 v[112:115], v[28:31], v[92:95], v[112:115]
  s_waitcnt lgkmcnt(6)
  v_mfma_f32_32x32x16_bf16 v[56:71], v[96:99], a[8:11], v[56:71]
  ds_read_b128 a[16:19], v11 offset:4096
  ds_read_b64_tr_b16 v[92:93], v7 offset:24576
  ds_read_b64_tr_b16 v[94:95], v7 offset:25600
  v_mfma_f32_16x16x32_bf16 v[112:115], v[28:31], v[96:99], v[112:115]
  s_waitcnt lgkmcnt(6)
  v_pk_add_f32 v[72:73], v[72:73], v[100:101]
  v_pk_add_f32 v[74:75], v[74:75], v[102:103]
  v_pk_add_f32 v[76:77], v[76:77], v[104:105]
  v_pk_add_f32 v[78:79], v[78:79], v[106:107]
  v_add_f32 v80, v80, v108
  s_lshl_b32 s58, s83, 13
  s_lshl_b32 s59, s48, 12
  s_add_u32 s58, s58, s59
  s_add_u32 s80, s58, 12582912
  s_lshl_b32 s59, s47, 31
  v_lshl_or_b32 v81, v1, 2, s59
  v_and_b32 v82, 31, v1
  v_lshl_or_b32 v82, v82, 2, s59
  s_waitcnt lgkmcnt(3)
  v_mfma_f32_32x32x16_bf16 v[56:71], v[88:91], a[12:15], v[56:71]
  ds_read_b128 a[20:23], v11 offset:5120
  ds_read_b64_tr_b16 v[96:97], v7 offset:26624
  ds_read_b64_tr_b16 v[98:99], v7 offset:27648
  v_mfma_f32_16x16x32_bf16 v[112:115], v[28:31], v[88:91], v[112:115]
  s_waitcnt lgkmcnt(3)
  v_mfma_f32_32x32x16_bf16 v[56:71], v[92:95], a[16:19], v[56:71]
  ds_read_b128 a[24:27], v11 offset:6144
  ds_read_b64_tr_b16 v[88:89], v7 offset:28672
  ds_read_b64_tr_b16 v[90:91], v7 offset:29696
  v_mfma_f32_16x16x32_bf16 v[112:115], v[28:31], v[92:95], v[112:115]
  s_waitcnt lgkmcnt(3)
  v_mfma_f32_32x32x16_bf16 v[56:71], v[96:99], a[20:23], v[56:71]
  ds_read_b128 a[28:31], v11 offset:7168
  ds_read_b64_tr_b16 v[92:93], v7 offset:30720
  ds_read_b64_tr_b16 v[94:95], v7 offset:31744
  v_mfma_f32_16x16x32_bf16 v[112:115], v[28:31], v[96:99], v[112:115]
  s_waitcnt lgkmcnt(3)
  v_mfma_f32_32x32x16_bf16 v[56:71], v[88:91], a[24:27], v[56:71]
  s_waitcnt lgkmcnt(0)
  s_barrier
  ds_read_b128 a[64:67], v9 offset:0
  ds_read_b64_tr_b16 v[96:97], v7 offset:32768
  ds_read_b64_tr_b16 v[98:99], v7 offset:33792
  v_mfma_f32_16x16x32_bf16 v[112:115], v[28:31], v[88:91], v[112:115]
  buffer_atomic_add_f32 v72, v81, s[36:39], s80 offen offset:0 sc1
  v_mfma_f32_32x32x16_bf16 v[56:71], v[92:95], a[28:31], v[56:71]
  ds_read_b128 a[68:71], v9 offset:1024
  ds_read_b64_tr_b16 v[88:89], v7 offset:34816
  ds_read_b64_tr_b16 v[90:91], v7 offset:35840
  v_mfma_f32_16x16x32_bf16 v[112:115], v[28:31], v[92:95], v[112:115]
  s_waitcnt lgkmcnt(3)
  v_mfma_f32_32x32x16_bf16 v[56:71], v[96:99], a[64:67], v[56:71]
  ds_read_b128 a[72:75], v9 offset:2048
  ds_read_b64_tr_b16 v[92:93], v7 offset:36864
  ds_read_b64_tr_b16 v[94:95], v7 offset:37888
  v_mfma_f32_16x16x32_bf16 v[112:115], v[28:31], v[96:99], v[112:115]
  s_waitcnt lgkmcnt(3)
  v_mfma_f32_32x32x16_bf16 v[56:71], v[88:91], a[68:71], v[56:71]
  ds_read_b128 a[76:79], v9 offset:3072
  ds_read_b64_tr_b16 v[96:97], v7 offset:38912
  ds_read_b64_tr_b16 v[98:99], v7 offset:39936
  v_mfma_f32_16x16x32_bf16 v[112:115], v[28:31], v[88:91], v[112:115]
  s_waitcnt lgkmcnt(3)
  v_mfma_f32_32x32x16_bf16 v[56:71], v[92:95], a[72:75], v[56:71]
  ds_read_b128 a[80:83], v9 offset:4096
  ds_read_b64_tr_b16 v[88:89], v7 offset:40960
  ds_read_b64_tr_b16 v[90:91], v7 offset:41984
  v_mfma_f32_16x16x32_bf16 v[112:115], v[28:31], v[92:95], v[112:115]
  s_waitcnt lgkmcnt(3)
  v_mfma_f32_32x32x16_bf16 v[56:71], v[96:99], a[76:79], v[56:71]
  ds_read_b128 a[84:87], v9 offset:5120
  ds_read_b64_tr_b16 v[92:93], v7 offset:43008
  ds_read_b64_tr_b16 v[94:95], v7 offset:44032
  v_mfma_f32_16x16x32_bf16 v[112:115], v[28:31], v[96:99], v[112:115]
  s_waitcnt lgkmcnt(3)
  v_mfma_f32_32x32x16_bf16 v[56:71], v[88:91], a[80:83], v[56:71]
  ds_read_b128 a[88:91], v9 offset:6144
  ds_read_b64_tr_b16 v[96:97], v7 offset:45056
  ds_read_b64_tr_b16 v[98:99], v7 offset:46080
  v_mfma_f32_16x16x32_bf16 v[112:115], v[28:31], v[88:91], v[112:115]
  buffer_atomic_add_f32 v73, v81, s[36:39], s80 offen offset:256 sc1
  s_waitcnt lgkmcnt(3)
  v_mfma_f32_32x32x16_bf16 v[56:71], v[92:95], a[84:87], v[56:71]
  ds_read_b128 a[92:95], v9 offset:7168
  ds_read_b64_tr_b16 v[88:89], v7 offset:47104
  ds_read_b64_tr_b16 v[90:91], v7 offset:48128
  v_mfma_f32_16x16x32_bf16 v[112:115], v[28:31], v[92:95], v[112:115]
  s_waitcnt lgkmcnt(3)
  v_mfma_f32_32x32x16_bf16 v[56:71], v[96:99], a[88:91], v[56:71]
  s_waitcnt lgkmcnt(0)
  s_barrier
  ds_read_b128 a[96:99], v9 offset:16384
  ds_read_b64_tr_b16 v[92:93], v6 offset:32768
  ds_read_b64_tr_b16 v[94:95], v6 offset:33792
  v_mfma_f32_16x16x32_bf16 v[112:115], v[28:31], v[96:99], v[112:115]
  v_mfma_f32_32x32x16_bf16 v[56:71], v[88:91], a[92:95], v[56:71]
  ds_read_b128 a[100:103], v9 offset:17408
  ds_read_b64_tr_b16 v[96:97], v6 offset:34816
  ds_read_b64_tr_b16 v[98:99], v6 offset:35840
  v_mfma_f32_16x16x32_bf16 v[112:115], v[28:31], v[88:91], v[112:115]
  s_waitcnt lgkmcnt(3)
  v_mfma_f32_32x32x16_bf16 v[56:71], v[92:95], a[96:99], v[56:71]
  ds_read_b128 a[104:107], v9 offset:18432
  ds_read_b64_tr_b16 v[88:89], v6 offset:36864
  ds_read_b64_tr_b16 v[90:91], v6 offset:37888
  v_mfma_f32_16x16x32_bf16 v[112:115], v[28:31], v[92:95], v[112:115]
  s_waitcnt lgkmcnt(3)
  v_mfma_f32_32x32x16_bf16 v[56:71], v[96:99], a[100:103], v[56:71]
  ds_read_b128 a[108:111], v9 offset:19456
  ds_read_b64_tr_b16 v[92:93], v6 offset:38912
  ds_read_b64_tr_b16 v[94:95], v6 offset:39936
  v_mfma_f32_16x16x32_bf16 v[112:115], v[28:31], v[96:99], v[112:115]
  s_waitcnt lgkmcnt(3)
  v_mfma_f32_32x32x16_bf16 v[56:71], v[88:91], a[104:107], v[56:71]
  ds_read_b128 a[112:115], v9 offset:20480
  ds_read_b64_tr_b16 v[96:97], v6 offset:40960
  ds_read_b64_tr_b16 v[98:99], v6 offset:41984
  v_mfma_f32_16x16x32_bf16 v[112:115], v[28:31], v[88:91], v[112:115]
  buffer_atomic_add_f32 v74, v81, s[36:39], s80 offen offset:512 sc1
  s_waitcnt lgkmcnt(3)
  v_mfma_f32_32x32x16_bf16 v[56:71], v[92:95], a[108:111], v[56:71]
  ds_read_b128 a[116:119], v9 offset:21504
  ds_read_b64_tr_b16 v[88:89], v6 offset:43008
  ds_read_b64_tr_b16 v[90:91], v6 offset:44032
  v_mfma_f32_16x16x32_bf16 v[112:115], v[28:31], v[92:95], v[112:115]
  s_waitcnt lgkmcnt(3)
  v_mfma_f32_32x32x16_bf16 v[56:71], v[96:99], a[112:115], v[56:71]
  ds_read_b128 a[120:123], v9 offset:22528
  ds_read_b64_tr_b16 v[92:93], v6 offset:45056
  ds_read_b64_tr_b16 v[94:95], v6 offset:46080
  v_mfma_f32_16x16x32_bf16 v[112:115], v[28:31], v[96:99], v[112:115]
  s_waitcnt lgkmcnt(3)
  v_mfma_f32_32x32x16_bf16 v[56:71], v[88:91], a[116:119], v[56:71]
  ds_read_b128 a[124:127], v9 offset:23552
  ds_read_b64_tr_b16 v[96:97], v6 offset:47104
  ds_read_b64_tr_b16 v[98:99], v6 offset:48128
  v_mfma_f32_16x16x32_bf16 v[112:115], v[28:31], v[88:91], v[112:115]
  s_waitcnt lgkmcnt(3)
  v_mfma_f32_32x32x16_bf16 v[56:71], v[92:95], a[120:123], v[56:71]
  s_waitcnt lgkmcnt(0)
  s_barrier
  ds_read_b128 a[32:35], v9 offset:49152
  ds_read_b64_tr_b16 v[88:89], v7 offset:49152
  ds_read_b64_tr_b16 v[90:91], v7 offset:50176
  v_mfma_f32_16x16x32_bf16 v[112:115], v[28:31], v[92:95], v[112:115]
  v_mfma_f32_32x32x16_bf16 v[56:71], v[96:99], a[124:127], v[56:71]
  ds_read_b128 a[36:39], v9 offset:50176
  ds_read_b64_tr_b16 v[92:93], v7 offset:51200
  ds_read_b64_tr_b16 v[94:95], v7 offset:52224
  v_mfma_f32_16x16x32_bf16 v[112:115], v[28:31], v[96:99], v[112:115]
  s_waitcnt lgkmcnt(3)
  v_mfma_f32_32x32x16_bf16 v[56:71], v[88:91], a[32:35], v[56:71]
  ds_read_b128 a[40:43], v9 offset:51200
  ds_read_b64_tr_b16 v[96:97], v7 offset:53248
  ds_read_b64_tr_b16 v[98:99], v7 offset:54272
  v_mfma_f32_16x16x32_bf16 v[112:115], v[28:31], v[88:91], v[112:115]
  buffer_atomic_add_f32 v75, v81, s[36:39], s80 offen offset:768 sc1
  s_waitcnt lgkmcnt(3)
  v_mfma_f32_32x32x16_bf16 v[56:71], v[92:95], a[36:39], v[56:71]
  ds_read_b128 a[44:47], v9 offset:52224
  ds_read_b64_tr_b16 v[88:89], v7 offset:55296
  ds_read_b64_tr_b16 v[90:91], v7 offset:56320
  v_mfma_f32_16x16x32_bf16 v[112:115], v[28:31], v[92:95], v[112:115]
  s_waitcnt lgkmcnt(3)
  v_mfma_f32_32x32x16_bf16 v[56:71], v[96:99], a[40:43], v[56:71]
  ds_read_b128 a[48:51], v9 offset:53248
  ds_read_b64_tr_b16 v[92:93], v7 offset:57344
  ds_read_b64_tr_b16 v[94:95], v7 offset:58368
  v_mfma_f32_16x16x32_bf16 v[112:115], v[28:31], v[96:99], v[112:115]
  s_waitcnt lgkmcnt(3)
  v_mfma_f32_32x32x16_bf16 v[56:71], v[88:91], a[44:47], v[56:71]
  ds_read_b128 a[52:55], v9 offset:54272
  ds_read_b64_tr_b16 v[96:97], v7 offset:59392
  ds_read_b64_tr_b16 v[98:99], v7 offset:60416
  v_mfma_f32_16x16x32_bf16 v[112:115], v[28:31], v[88:91], v[112:115]
  s_waitcnt lgkmcnt(3)
  v_mfma_f32_32x32x16_bf16 v[56:71], v[92:95], a[48:51], v[56:71]
  ds_read_b128 a[56:59], v9 offset:55296
  ds_read_b64_tr_b16 v[88:89], v7 offset:61440
  ds_read_b64_tr_b16 v[90:91], v7 offset:62464
  v_mfma_f32_16x16x32_bf16 v[112:115], v[28:31], v[92:95], v[112:115]
  s_waitcnt lgkmcnt(3)
  v_mfma_f32_32x32x16_bf16 v[56:71], v[96:99], a[52:55], v[56:71]
  ds_read_b128 a[60:63], v9 offset:56320
  ds_read_b64_tr_b16 v[92:93], v7 offset:63488
  ds_read_b64_tr_b16 v[94:95], v7 offset:64512
  v_mfma_f32_16x16x32_bf16 v[112:115], v[28:31], v[96:99], v[112:115]
  s_waitcnt lgkmcnt(3)
  v_mfma_f32_32x32x16_bf16 v[56:71], v[88:91], a[56:59], v[56:71]
  v_mfma_f32_16x16x32_bf16 v[112:115], v[28:31], v[88:91], v[112:115]
  buffer_atomic_add_f32 v76, v81, s[36:39], s80 offen offset:1024 sc1
  s_waitcnt lgkmcnt(0)
  v_mfma_f32_32x32x16_bf16 v[56:71], v[92:95], a[60:63], v[56:71]
  v_mfma_f32_16x16x32_bf16 v[112:115], v[28:31], v[92:95], v[112:115]
  s_barrier
  v_and_b32 v13, 31, v1
  v_lshlrev_b32 v13, 3, v13
  v_lshrrev_b32 v16, 5, v1
  v_lshl_add_u32 v13, v16, 11, v13
  s_lshl_b32 s58, s47, 12
  s_add_u32 s58, s58, 154112
  v_add_u32 v13, s58, v13
  ds_read_b64 v[88:89], v13 offset:0
  ds_read_b64 v[90:91], v13 offset:256
  ds_read_b64 v[92:93], v13 offset:512
  ds_read_b64 v[94:95], v13 offset:768
  ds_read_b64 v[96:97], v13 offset:1024
  ds_read_b64 v[98:99], v13 offset:1280
  ds_read_b64 v[100:101], v13 offset:1536
  ds_read_b64 v[102:103], v13 offset:1792
  s_waitcnt lgkmcnt(0)
  v_pk_add_f32 v[88:89], v[88:89], v[90:91]
  v_pk_add_f32 v[88:89], v[88:89], v[92:93]
  v_pk_add_f32 v[88:89], v[88:89], v[94:95]
  v_pk_add_f32 v[88:89], v[88:89], v[96:97]
  v_pk_add_f32 v[88:89], v[88:89], v[98:99]
  v_pk_add_f32 v[88:89], v[88:89], v[100:101]
  v_pk_add_f32 v[88:89], v[88:89], v[102:103]
  v_mov_b32 v90, v88
  v_mov_b32 v91, v89
  s_nop 1
  v_permlane32_swap_b32 v88, v90
  v_permlane32_swap_b32 v89, v91
  s_nop 0
  v_add_f32 v88, v88, v90
  v_add_f32 v89, v89, v91
  v_mul_f32 v22, 0x3b000000, v88
  v_mul_f32 v89, 0x3b000000, v89
  v_fma_f32 v89, -v22, v22, v89
  v_max_f32 v89, 0, v89
  v_add_f32 v88, 0x3727c5ac, v89
  v_rsq_f32 v24, v88
  s_nop 0
  v_sub_f32 v21, 0, v22
  s_nop 1
  v_fmac_f32_dpp v56, v112, v21 row_newbcast:0 row_mask:0x3 bank_mask:0xf
  v_fmac_f32_dpp v56, v112, v21 row_newbcast:4 row_mask:0xc bank_mask:0xf
  v_fmac_f32_dpp v57, v112, v21 row_newbcast:1 row_mask:0x3 bank_mask:0xf
  v_fmac_f32_dpp v57, v112, v21 row_newbcast:5 row_mask:0xc bank_mask:0xf
  v_fmac_f32_dpp v58, v112, v21 row_newbcast:2 row_mask:0x3 bank_mask:0xf
  v_fmac_f32_dpp v58, v112, v21 row_newbcast:6 row_mask:0xc bank_mask:0xf
  v_fmac_f32_dpp v59, v112, v21 row_newbcast:3 row_mask:0x3 bank_mask:0xf
  v_fmac_f32_dpp v59, v112, v21 row_newbcast:7 row_mask:0xc bank_mask:0xf
  v_fmac_f32_dpp v60, v112, v21 row_newbcast:8 row_mask:0x3 bank_mask:0xf
  v_fmac_f32_dpp v60, v112, v21 row_newbcast:12 row_mask:0xc bank_mask:0xf
  v_fmac_f32_dpp v61, v112, v21 row_newbcast:9 row_mask:0x3 bank_mask:0xf
  v_fmac_f32_dpp v61, v112, v21 row_newbcast:13 row_mask:0xc bank_mask:0xf
  v_fmac_f32_dpp v62, v112, v21 row_newbcast:10 row_mask:0x3 bank_mask:0xf
  v_fmac_f32_dpp v62, v112, v21 row_newbcast:14 row_mask:0xc bank_mask:0xf
  v_fmac_f32_dpp v63, v112, v21 row_newbcast:11 row_mask:0x3 bank_mask:0xf
  v_fmac_f32_dpp v63, v112, v21 row_newbcast:15 row_mask:0xc bank_mask:0xf
  v_fmac_f32_dpp v64, v113, v21 row_newbcast:0 row_mask:0x3 bank_mask:0xf
  v_fmac_f32_dpp v64, v113, v21 row_newbcast:4 row_mask:0xc bank_mask:0xf
  v_fmac_f32_dpp v65, v113, v21 row_newbcast:1 row_mask:0x3 bank_mask:0xf
  v_fmac_f32_dpp v65, v113, v21 row_newbcast:5 row_mask:0xc bank_mask:0xf
  v_fmac_f32_dpp v66, v113, v21 row_newbcast:2 row_mask:0x3 bank_mask:0xf
  v_fmac_f32_dpp v66, v113, v21 row_newbcast:6 row_mask:0xc bank_mask:0xf
  v_fmac_f32_dpp v67, v113, v21 row_newbcast:3 row_mask:0x3 bank_mask:0xf
  v_fmac_f32_dpp v67, v113, v21 row_newbcast:7 row_mask:0xc bank_mask:0xf
  v_fmac_f32_dpp v68, v113, v21 row_newbcast:8 row_mask:0x3 bank_mask:0xf
  v_fmac_f32_dpp v68, v113, v21 row_newbcast:12 row_mask:0xc bank_mask:0xf
  v_fmac_f32_dpp v69, v113, v21 row_newbcast:9 row_mask:0x3 bank_mask:0xf
  v_fmac_f32_dpp v69, v113, v21 row_newbcast:13 row_mask:0xc bank_mask:0xf
  v_fmac_f32_dpp v70, v113, v21 row_newbcast:10 row_mask:0x3 bank_mask:0xf
  v_fmac_f32_dpp v70, v113, v21 row_newbcast:14 row_mask:0xc bank_mask:0xf
  v_fmac_f32_dpp v71, v113, v21 row_newbcast:11 row_mask:0x3 bank_mask:0xf
  v_fmac_f32_dpp v71, v113, v21 row_newbcast:15 row_mask:0xc bank_mask:0xf
  v_pk_mul_f32 v[56:57], v[56:57], v[24:25] op_sel_hi:[1,0]
  v_pk_mul_f32 v[58:59], v[58:59], v[24:25] op_sel_hi:[1,0]
  v_pk_mul_f32 v[60:61], v[60:61], v[24:25] op_sel_hi:[1,0]
  v_pk_mul_f32 v[62:63], v[62:63], v[24:25] op_sel_hi:[1,0]
  v_pk_mul_f32 v[64:65], v[64:65], v[24:25] op_sel_hi:[1,0]
  v_pk_mul_f32 v[66:67], v[66:67], v[24:25] op_sel_hi:[1,0]
  v_pk_mul_f32 v[68:69], v[68:69], v[24:25] op_sel_hi:[1,0]
  v_pk_mul_f32 v[70:71], v[70:71], v[24:25] op_sel_hi:[1,0]
  v_pk_mul_f32 v[88:89], v[56:57], v[56:57]
  v_pk_mul_f32 v[90:91], v[58:59], v[58:59]
  v_pk_mul_f32 v[92:93], v[60:61], v[60:61]
  v_pk_mul_f32 v[94:95], v[62:63], v[62:63]
  v_pk_mul_f32 v[96:97], v[64:65], v[64:65]
  v_pk_mul_f32 v[98:99], v[66:67], v[66:67]
  v_pk_mul_f32 v[100:101], v[68:69], v[68:69]
  v_pk_mul_f32 v[102:103], v[70:71], v[70:71]
  v_pk_fma_f32 v[88:89], v[88:89], s[64:65], v[26:27]
  v_pk_fma_f32 v[90:91], v[90:91], s[64:65], v[26:27]
  v_pk_fma_f32 v[92:93], v[92:93], s[64:65], v[26:27]
  v_pk_fma_f32 v[94:95], v[94:95], s[64:65], v[26:27]
  v_pk_fma_f32 v[96:97], v[96:97], s[64:65], v[26:27]
  v_pk_fma_f32 v[98:99], v[98:99], s[64:65], v[26:27]
  v_pk_fma_f32 v[100:101], v[100:101], s[64:65], v[26:27]
  v_pk_fma_f32 v[102:103], v[102:103], s[64:65], v[26:27]
  v_pk_mul_f32 v[88:89], v[88:89], v[56:57]
  v_pk_mul_f32 v[90:91], v[90:91], v[58:59]
  v_pk_mul_f32 v[92:93], v[92:93], v[60:61]
  v_pk_mul_f32 v[94:95], v[94:95], v[62:63]
  v_pk_mul_f32 v[96:97], v[96:97], v[64:65]
  v_pk_mul_f32 v[98:99], v[98:99], v[66:67]
  v_pk_mul_f32 v[100:101], v[100:101], v[68:69]
  v_pk_mul_f32 v[102:103], v[102:103], v[70:71]
  v_exp_f32 v88, v88
  v_exp_f32 v89, v89
  v_exp_f32 v90, v90
  v_exp_f32 v91, v91
  v_exp_f32 v92, v92
  v_exp_f32 v93, v93
  v_exp_f32 v94, v94
  v_exp_f32 v95, v95
  v_exp_f32 v96, v96
  v_exp_f32 v97, v97
  v_exp_f32 v98, v98
  v_exp_f32 v99, v99
  v_exp_f32 v100, v100
  v_exp_f32 v101, v101
  v_exp_f32 v102, v102
  v_exp_f32 v103, v103
  v_pk_add_f32 v[88:89], v[88:89], s[66:67]
  v_pk_add_f32 v[90:91], v[90:91], s[66:67]
  v_pk_add_f32 v[92:93], v[92:93], s[66:67]
  v_pk_add_f32 v[94:95], v[94:95], s[66:67]
  v_pk_add_f32 v[96:97], v[96:97], s[66:67]
  v_pk_add_f32 v[98:99], v[98:99], s[66:67]
  v_pk_add_f32 v[100:101], v[100:101], s[66:67]
  v_pk_add_f32 v[102:103], v[102:103], s[66:67]
  v_rcp_f32 v88, v88
  v_rcp_f32 v89, v89
  v_rcp_f32 v90, v90
  v_rcp_f32 v91, v91
  v_rcp_f32 v92, v92
  v_rcp_f32 v93, v93
  v_rcp_f32 v94, v94
  v_rcp_f32 v95, v95
  v_rcp_f32 v96, v96
  v_rcp_f32 v97, v97
  v_rcp_f32 v98, v98
  v_rcp_f32 v99, v99
  v_rcp_f32 v100, v100
  v_rcp_f32 v101, v101
  v_rcp_f32 v102, v102
  v_rcp_f32 v103, v103
  v_pk_mul_f32 v[56:57], v[56:57], v[88:89]
  v_pk_mul_f32 v[58:59], v[58:59], v[90:91]
  v_pk_mul_f32 v[60:61], v[60:61], v[92:93]
  v_pk_mul_f32 v[62:63], v[62:63], v[94:95]
  v_pk_mul_f32 v[64:65], v[64:65], v[96:97]
  v_pk_mul_f32 v[66:67], v[66:67], v[98:99]
  v_pk_mul_f32 v[68:69], v[68:69], v[100:101]
  v_pk_mul_f32 v[70:71], v[70:71], v[102:103]
  v_cvt_pk_bf16_f32 v120, v56, v57
  v_cvt_pk_bf16_f32 v121, v58, v59
  v_cvt_pk_bf16_f32 v122, v60, v61
  v_cvt_pk_bf16_f32 v123, v62, v63
  v_cvt_pk_bf16_f32 v124, v64, v65
  v_cvt_pk_bf16_f32 v125, v66, v67
  v_cvt_pk_bf16_f32 v126, v68, v69
  v_cvt_pk_bf16_f32 v127, v70, v71
  s_mul_i32 s58, s60, 98304
  s_mul_i32 s59, s45, 12288
  s_add_u32 s58, s58, s59
  s_lshl_b32 s59, s48, 11
  s_add_u32 s58, s58, s59
  s_add_u32 s58, s58, 6291456
  buffer_store_dwordx4 v[120:123], v2, s[36:39], s58 offen sc1
  buffer_store_dwordx4 v[124:127], v2, s[36:39], s58 offen offset:1024 sc1
  s_barrier
  ds_read_b64_tr_b16 v[88:89], v7 offset:0
  ds_read_b64_tr_b16 v[90:91], v7 offset:1024
  ds_read_b64_tr_b16 v[92:93], v7 offset:2048
  ds_read_b64_tr_b16 v[94:95], v7 offset:3072
  s_waitcnt lgkmcnt(2)
  v_mfma_f32_32x32x16_bf16 v[56:71], v[88:91], a[0:3], 0
  ds_read_b64_tr_b16 v[96:97], v7 offset:4096
  ds_read_b64_tr_b16 v[98:99], v7 offset:5120
  v_mfma_f32_16x16x32_bf16 v[112:115], v[28:31], v[88:91], 0
  s_waitcnt lgkmcnt(2)
  v_mfma_f32_32x32x16_bf16 v[56:71], v[92:95], a[4:7], v[56:71]
  ds_read_b64_tr_b16 v[88:89], v7 offset:6144
  ds_read_b64_tr_b16 v[90:91], v7 offset:7168
  v_mfma_f32_16x16x32_bf16 v[112:115], v[28:31], v[92:95], v[112:115]
  s_waitcnt lgkmcnt(2)
  v_mfma_f32_32x32x16_bf16 v[56:71], v[96:99], a[8:11], v[56:71]
  ds_read_b64_tr_b16 v[92:93], v7 offset:8192
  ds_read_b64_tr_b16 v[94:95], v7 offset:9216
  v_mfma_f32_16x16x32_bf16 v[112:115], v[28:31], v[96:99], v[112:115]
  s_waitcnt lgkmcnt(2)
  v_mfma_f32_32x32x16_bf16 v[56:71], v[88:91], a[12:15], v[56:71]
  ds_read_b64_tr_b16 v[96:97], v7 offset:10240
  ds_read_b64_tr_b16 v[98:99], v7 offset:11264
  v_mfma_f32_16x16x32_bf16 v[112:115], v[28:31], v[88:91], v[112:115]
  s_waitcnt lgkmcnt(2)
  v_mfma_f32_32x32x16_bf16 v[56:71], v[92:95], a[16:19], v[56:71]
  ds_read_b64_tr_b16 v[88:89], v7 offset:12288
  ds_read_b64_tr_b16 v[90:91], v7 offset:13312
  v_mfma_f32_16x16x32_bf16 v[112:115], v[28:31], v[92:95], v[112:115]
  s_waitcnt lgkmcnt(2)
  v_mfma_f32_32x32x16_bf16 v[56:71], v[96:99], a[20:23], v[56:71]
  ds_read_b64_tr_b16 v[92:93], v7 offset:14336
  ds_read_b64_tr_b16 v[94:95], v7 offset:15360
  v_mfma_f32_16x16x32_bf16 v[112:115], v[28:31], v[96:99], v[112:115]
  s_waitcnt lgkmcnt(2)
  v_mfma_f32_32x32x16_bf16 v[56:71], v[88:91], a[24:27], v[56:71]
  s_waitcnt lgkmcnt(0)
  s_barrier
  ds_read_b64_tr_b16 v[96:97], v8 offset:0
  ds_read_b64_tr_b16 v[98:99], v8 offset:1024
  v_mfma_f32_16x16x32_bf16 v[112:115], v[28:31], v[88:91], v[112:115]
  buffer_atomic_add_f32 v77, v81, s[36:39], s80 offen offset:1280 sc1
  v_mfma_f32_32x32x16_bf16 v[56:71], v[92:95], a[28:31], v[56:71]
  ds_read_b64_tr_b16 v[88:89], v8 offset:2048
  ds_read_b64_tr_b16 v[90:91], v8 offset:3072
  v_mfma_f32_16x16x32_bf16 v[112:115], v[28:31], v[92:95], v[112:115]
  s_waitcnt lgkmcnt(2)
  v_mfma_f32_32x32x16_bf16 v[56:71], v[96:99], a[32:35], v[56:71]
  ds_read_b64_tr_b16 v[92:93], v8 offset:4096
  ds_read_b64_tr_b16 v[94:95], v8 offset:5120
  v_mfma_f32_16x16x32_bf16 v[112:115], v[28:31], v[96:99], v[112:115]
  s_waitcnt lgkmcnt(2)
  v_mfma_f32_32x32x16_bf16 v[56:71], v[88:91], a[36:39], v[56:71]
  ds_read_b64_tr_b16 v[96:97], v8 offset:6144
  ds_read_b64_tr_b16 v[98:99], v8 offset:7168
  v_mfma_f32_16x16x32_bf16 v[112:115], v[28:31], v[88:91], v[112:115]
  s_waitcnt lgkmcnt(2)
  v_mfma_f32_32x32x16_bf16 v[56:71], v[92:95], a[40:43], v[56:71]
  ds_read_b64_tr_b16 v[88:89], v8 offset:8192
  ds_read_b64_tr_b16 v[90:91], v8 offset:9216
  v_mfma_f32_16x16x32_bf16 v[112:115], v[28:31], v[92:95], v[112:115]
  s_waitcnt lgkmcnt(2)
  v_mfma_f32_32x32x16_bf16 v[56:71], v[96:99], a[44:47], v[56:71]
  ds_read_b64_tr_b16 v[92:93], v8 offset:10240
  ds_read_b64_tr_b16 v[94:95], v8 offset:11264
  v_mfma_f32_16x16x32_bf16 v[112:115], v[28:31], v[96:99], v[112:115]
  s_waitcnt lgkmcnt(2)
  v_mfma_f32_32x32x16_bf16 v[56:71], v[88:91], a[48:51], v[56:71]
  ds_read_b64_tr_b16 v[96:97], v8 offset:12288
  ds_read_b64_tr_b16 v[98:99], v8 offset:13312
  v_mfma_f32_16x16x32_bf16 v[112:115], v[28:31], v[88:91], v[112:115]
  buffer_atomic_add_f32 v78, v81, s[36:39], s80 offen offset:1536 sc1
  s_waitcnt lgkmcnt(2)
  v_mfma_f32_32x32x16_bf16 v[56:71], v[92:95], a[52:55], v[56:71]
  ds_read_b64_tr_b16 v[88:89], v8 offset:14336
  ds_read_b64_tr_b16 v[90:91], v8 offset:15360
  v_mfma_f32_16x16x32_bf16 v[112:115], v[28:31], v[92:95], v[112:115]
  s_waitcnt lgkmcnt(2)
  v_mfma_f32_32x32x16_bf16 v[56:71], v[96:99], a[56:59], v[56:71]
  s_waitcnt lgkmcnt(0)
  s_barrier
  ds_read_b64_tr_b16 v[92:93], v7 offset:16384
  ds_read_b64_tr_b16 v[94:95], v7 offset:17408
  v_mfma_f32_16x16x32_bf16 v[112:115], v[28:31], v[96:99], v[112:115]
  v_mfma_f32_32x32x16_bf16 v[56:71], v[88:91], a[60:63], v[56:71]
  ds_read_b64_tr_b16 v[96:97], v7 offset:18432
  ds_read_b64_tr_b16 v[98:99], v7 offset:19456
  v_mfma_f32_16x16x32_bf16 v[112:115], v[28:31], v[88:91], v[112:115]
  s_waitcnt lgkmcnt(2)
  v_mfma_f32_32x32x16_bf16 v[56:71], v[92:95], a[64:67], v[56:71]
  ds_read_b64_tr_b16 v[88:89], v7 offset:20480
  ds_read_b64_tr_b16 v[90:91], v7 offset:21504
  v_mfma_f32_16x16x32_bf16 v[112:115], v[28:31], v[92:95], v[112:115]
  s_waitcnt lgkmcnt(2)
  v_mfma_f32_32x32x16_bf16 v[56:71], v[96:99], a[68:71], v[56:71]
  ds_read_b64_tr_b16 v[92:93], v7 offset:22528
  ds_read_b64_tr_b16 v[94:95], v7 offset:23552
  v_mfma_f32_16x16x32_bf16 v[112:115], v[28:31], v[96:99], v[112:115]
  s_waitcnt lgkmcnt(2)
  v_mfma_f32_32x32x16_bf16 v[56:71], v[88:91], a[72:75], v[56:71]
  ds_read_b64_tr_b16 v[96:97], v7 offset:24576
  ds_read_b64_tr_b16 v[98:99], v7 offset:25600
  v_mfma_f32_16x16x32_bf16 v[112:115], v[28:31], v[88:91], v[112:115]
  buffer_atomic_add_f32 v79, v81, s[36:39], s80 offen offset:1792 sc1
  s_waitcnt lgkmcnt(2)
  v_mfma_f32_32x32x16_bf16 v[56:71], v[92:95], a[76:79], v[56:71]
  ds_read_b64_tr_b16 v[88:89], v7 offset:26624
  ds_read_b64_tr_b16 v[90:91], v7 offset:27648
  v_mfma_f32_16x16x32_bf16 v[112:115], v[28:31], v[92:95], v[112:115]
  s_waitcnt lgkmcnt(2)
  v_mfma_f32_32x32x16_bf16 v[56:71], v[96:99], a[80:83], v[56:71]
  ds_read_b64_tr_b16 v[92:93], v7 offset:28672
  ds_read_b64_tr_b16 v[94:95], v7 offset:29696
  v_mfma_f32_16x16x32_bf16 v[112:115], v[28:31], v[96:99], v[112:115]
  s_waitcnt lgkmcnt(2)
  v_mfma_f32_32x32x16_bf16 v[56:71], v[88:91], a[84:87], v[56:71]
  ds_read_b64_tr_b16 v[96:97], v7 offset:30720
  ds_read_b64_tr_b16 v[98:99], v7 offset:31744
  v_mfma_f32_16x16x32_bf16 v[112:115], v[28:31], v[88:91], v[112:115]
  s_waitcnt lgkmcnt(2)
  v_mfma_f32_32x32x16_bf16 v[56:71], v[92:95], a[88:91], v[56:71]
  s_waitcnt lgkmcnt(0)
  s_waitcnt vmcnt(3)
  s_barrier
  s_lshl_b32 s76, s44, 7
  s_lshl_b32 s77, s45, 2
  s_add_u32 s76, s76, s77
  s_add_u32 s76, s76, 12726272
  v_mov_b32 v13, 1
  buffer_store_dword v13, v14, s[36:39], s76 offen sc1
  ds_read_b64_tr_b16 v[88:89], v6 offset:0
  ds_read_b64_tr_b16 v[90:91], v6 offset:1024
  v_mfma_f32_16x16x32_bf16 v[112:115], v[28:31], v[92:95], v[112:115]
  v_mfma_f32_32x32x16_bf16 v[56:71], v[96:99], a[92:95], v[56:71]
  ds_read_b64_tr_b16 v[92:93], v6 offset:2048
  ds_read_b64_tr_b16 v[94:95], v6 offset:3072
  v_mfma_f32_16x16x32_bf16 v[112:115], v[28:31], v[96:99], v[112:115]
  s_waitcnt lgkmcnt(2)
  v_mfma_f32_32x32x16_bf16 v[56:71], v[88:91], a[96:99], v[56:71]
  ds_read_b64_tr_b16 v[96:97], v6 offset:4096
  ds_read_b64_tr_b16 v[98:99], v6 offset:5120
  v_mfma_f32_16x16x32_bf16 v[112:115], v[28:31], v[88:91], v[112:115]
  buffer_atomic_add_f32 v80, v82, s[36:39], s80 offen offset:2048 sc1
  s_waitcnt lgkmcnt(2)
  v_mfma_f32_32x32x16_bf16 v[56:71], v[92:95], a[100:103], v[56:71]
  ds_read_b64_tr_b16 v[88:89], v6 offset:6144
  ds_read_b64_tr_b16 v[90:91], v6 offset:7168
  v_mfma_f32_16x16x32_bf16 v[112:115], v[28:31], v[92:95], v[112:115]
  s_waitcnt lgkmcnt(2)
  v_mfma_f32_32x32x16_bf16 v[56:71], v[96:99], a[104:107], v[56:71]
  ds_read_b64_tr_b16 v[92:93], v6 offset:8192
  ds_read_b64_tr_b16 v[94:95], v6 offset:9216
  v_mfma_f32_16x16x32_bf16 v[112:115], v[28:31], v[96:99], v[112:115]
  s_waitcnt lgkmcnt(2)
  v_mfma_f32_32x32x16_bf16 v[56:71], v[88:91], a[108:111], v[56:71]
  ds_read_b64_tr_b16 v[96:97], v6 offset:10240
  ds_read_b64_tr_b16 v[98:99], v6 offset:11264
  v_mfma_f32_16x16x32_bf16 v[112:115], v[28:31], v[88:91], v[112:115]
  s_waitcnt lgkmcnt(2)
  v_mfma_f32_32x32x16_bf16 v[56:71], v[92:95], a[112:115], v[56:71]
  ds_read_b64_tr_b16 v[88:89], v6 offset:12288
  ds_read_b64_tr_b16 v[90:91], v6 offset:13312
  v_mfma_f32_16x16x32_bf16 v[112:115], v[28:31], v[92:95], v[112:115]
  s_waitcnt lgkmcnt(2)
  v_mfma_f32_32x32x16_bf16 v[56:71], v[96:99], a[116:119], v[56:71]
  ds_read_b64_tr_b16 v[92:93], v6 offset:14336
  ds_read_b64_tr_b16 v[94:95], v6 offset:15360
  v_mfma_f32_16x16x32_bf16 v[112:115], v[28:31], v[96:99], v[112:115]
  s_waitcnt lgkmcnt(2)
  v_mfma_f32_32x32x16_bf16 v[56:71], v[88:91], a[120:123], v[56:71]
  v_mfma_f32_16x16x32_bf16 v[112:115], v[28:31], v[88:91], v[112:115]
  s_waitcnt lgkmcnt(0)
  v_mfma_f32_32x32x16_bf16 v[56:71], v[92:95], a[124:127], v[56:71]
  v_mfma_f32_16x16x32_bf16 v[112:115], v[28:31], v[92:95], v[112:115]
  s_barrier
  s_nop 10
  v_fmac_f32_dpp v56, v112, v21 row_newbcast:0 row_mask:0x3 bank_mask:0xf
  v_fmac_f32_dpp v56, v112, v21 row_newbcast:4 row_mask:0xc bank_mask:0xf
  v_fmac_f32_dpp v57, v112, v21 row_newbcast:1 row_mask:0x3 bank_mask:0xf
  v_fmac_f32_dpp v57, v112, v21 row_newbcast:5 row_mask:0xc bank_mask:0xf
  v_fmac_f32_dpp v58, v112, v21 row_newbcast:2 row_mask:0x3 bank_mask:0xf
  v_fmac_f32_dpp v58, v112, v21 row_newbcast:6 row_mask:0xc bank_mask:0xf
  v_fmac_f32_dpp v59, v112, v21 row_newbcast:3 row_mask:0x3 bank_mask:0xf
  v_fmac_f32_dpp v59, v112, v21 row_newbcast:7 row_mask:0xc bank_mask:0xf
  v_fmac_f32_dpp v60, v112, v21 row_newbcast:8 row_mask:0x3 bank_mask:0xf
  v_fmac_f32_dpp v60, v112, v21 row_newbcast:12 row_mask:0xc bank_mask:0xf
  v_fmac_f32_dpp v61, v112, v21 row_newbcast:9 row_mask:0x3 bank_mask:0xf
  v_fmac_f32_dpp v61, v112, v21 row_newbcast:13 row_mask:0xc bank_mask:0xf
  v_fmac_f32_dpp v62, v112, v21 row_newbcast:10 row_mask:0x3 bank_mask:0xf
  v_fmac_f32_dpp v62, v112, v21 row_newbcast:14 row_mask:0xc bank_mask:0xf
  v_fmac_f32_dpp v63, v112, v21 row_newbcast:11 row_mask:0x3 bank_mask:0xf
  v_fmac_f32_dpp v63, v112, v21 row_newbcast:15 row_mask:0xc bank_mask:0xf
  v_fmac_f32_dpp v64, v113, v21 row_newbcast:0 row_mask:0x3 bank_mask:0xf
  v_fmac_f32_dpp v64, v113, v21 row_newbcast:4 row_mask:0xc bank_mask:0xf
  v_fmac_f32_dpp v65, v113, v21 row_newbcast:1 row_mask:0x3 bank_mask:0xf
  v_fmac_f32_dpp v65, v113, v21 row_newbcast:5 row_mask:0xc bank_mask:0xf
  v_fmac_f32_dpp v66, v113, v21 row_newbcast:2 row_mask:0x3 bank_mask:0xf
  v_fmac_f32_dpp v66, v113, v21 row_newbcast:6 row_mask:0xc bank_mask:0xf
  v_fmac_f32_dpp v67, v113, v21 row_newbcast:3 row_mask:0x3 bank_mask:0xf
  v_fmac_f32_dpp v67, v113, v21 row_newbcast:7 row_mask:0xc bank_mask:0xf
  v_fmac_f32_dpp v68, v113, v21 row_newbcast:8 row_mask:0x3 bank_mask:0xf
  v_fmac_f32_dpp v68, v113, v21 row_newbcast:12 row_mask:0xc bank_mask:0xf
  v_fmac_f32_dpp v69, v113, v21 row_newbcast:9 row_mask:0x3 bank_mask:0xf
  v_fmac_f32_dpp v69, v113, v21 row_newbcast:13 row_mask:0xc bank_mask:0xf
  v_fmac_f32_dpp v70, v113, v21 row_newbcast:10 row_mask:0x3 bank_mask:0xf
  v_fmac_f32_dpp v70, v113, v21 row_newbcast:14 row_mask:0xc bank_mask:0xf
  v_fmac_f32_dpp v71, v113, v21 row_newbcast:11 row_mask:0x3 bank_mask:0xf
  v_fmac_f32_dpp v71, v113, v21 row_newbcast:15 row_mask:0xc bank_mask:0xf
  v_pk_mul_f32 v[56:57], v[56:57], v[24:25] op_sel_hi:[1,0]
  v_pk_mul_f32 v[58:59], v[58:59], v[24:25] op_sel_hi:[1,0]
  v_pk_mul_f32 v[60:61], v[60:61], v[24:25] op_sel_hi:[1,0]
  v_pk_mul_f32 v[62:63], v[62:63], v[24:25] op_sel_hi:[1,0]
  v_pk_mul_f32 v[64:65], v[64:65], v[24:25] op_sel_hi:[1,0]
  v_pk_mul_f32 v[66:67], v[66:67], v[24:25] op_sel_hi:[1,0]
  v_pk_mul_f32 v[68:69], v[68:69], v[24:25] op_sel_hi:[1,0]
  v_pk_mul_f32 v[70:71], v[70:71], v[24:25] op_sel_hi:[1,0]
  v_pk_mul_f32 v[88:89], v[56:57], v[56:57]
  v_pk_mul_f32 v[90:91], v[58:59], v[58:59]
  v_pk_mul_f32 v[92:93], v[60:61], v[60:61]
  v_pk_mul_f32 v[94:95], v[62:63], v[62:63]
  v_pk_mul_f32 v[96:97], v[64:65], v[64:65]
  v_pk_mul_f32 v[98:99], v[66:67], v[66:67]
  v_pk_mul_f32 v[100:101], v[68:69], v[68:69]
  v_pk_mul_f32 v[102:103], v[70:71], v[70:71]
  v_pk_fma_f32 v[88:89], v[88:89], s[64:65], v[26:27]
  v_pk_fma_f32 v[90:91], v[90:91], s[64:65], v[26:27]
  v_pk_fma_f32 v[92:93], v[92:93], s[64:65], v[26:27]
  v_pk_fma_f32 v[94:95], v[94:95], s[64:65], v[26:27]
  v_pk_fma_f32 v[96:97], v[96:97], s[64:65], v[26:27]
  v_pk_fma_f32 v[98:99], v[98:99], s[64:65], v[26:27]
  v_pk_fma_f32 v[100:101], v[100:101], s[64:65], v[26:27]
  v_pk_fma_f32 v[102:103], v[102:103], s[64:65], v[26:27]
  v_pk_mul_f32 v[88:89], v[88:89], v[56:57]
  v_pk_mul_f32 v[90:91], v[90:91], v[58:59]
  v_pk_mul_f32 v[92:93], v[92:93], v[60:61]
  v_pk_mul_f32 v[94:95], v[94:95], v[62:63]
  v_pk_mul_f32 v[96:97], v[96:97], v[64:65]
  v_pk_mul_f32 v[98:99], v[98:99], v[66:67]
  v_pk_mul_f32 v[100:101], v[100:101], v[68:69]
  v_pk_mul_f32 v[102:103], v[102:103], v[70:71]
  v_exp_f32 v88, v88
  v_exp_f32 v89, v89
  v_exp_f32 v90, v90
  v_exp_f32 v91, v91
  v_exp_f32 v92, v92
  v_exp_f32 v93, v93
  v_exp_f32 v94, v94
  v_exp_f32 v95, v95
  v_exp_f32 v96, v96
  v_exp_f32 v97, v97
  v_exp_f32 v98, v98
  v_exp_f32 v99, v99
  v_exp_f32 v100, v100
  v_exp_f32 v101, v101
  v_exp_f32 v102, v102
  v_exp_f32 v103, v103
  v_pk_add_f32 v[88:89], v[88:89], s[66:67]
  v_pk_add_f32 v[90:91], v[90:91], s[66:67]
  v_pk_add_f32 v[92:93], v[92:93], s[66:67]
  v_pk_add_f32 v[94:95], v[94:95], s[66:67]
  v_pk_add_f32 v[96:97], v[96:97], s[66:67]
  v_pk_add_f32 v[98:99], v[98:99], s[66:67]
  v_pk_add_f32 v[100:101], v[100:101], s[66:67]
  v_pk_add_f32 v[102:103], v[102:103], s[66:67]
  v_rcp_f32 v88, v88
  v_rcp_f32 v89, v89
  v_rcp_f32 v90, v90
  v_rcp_f32 v91, v91
  v_rcp_f32 v92, v92
  v_rcp_f32 v93, v93
  v_rcp_f32 v94, v94
  v_rcp_f32 v95, v95
  v_rcp_f32 v96, v96
  v_rcp_f32 v97, v97
  v_rcp_f32 v98, v98
  v_rcp_f32 v99, v99
  v_rcp_f32 v100, v100
  v_rcp_f32 v101, v101
  v_rcp_f32 v102, v102
  v_rcp_f32 v103, v103
  v_pk_mul_f32 v[56:57], v[56:57], v[88:89]
  v_pk_mul_f32 v[58:59], v[58:59], v[90:91]
  v_pk_mul_f32 v[60:61], v[60:61], v[92:93]
  v_pk_mul_f32 v[62:63], v[62:63], v[94:95]
  v_pk_mul_f32 v[64:65], v[64:65], v[96:97]
  v_pk_mul_f32 v[66:67], v[66:67], v[98:99]
  v_pk_mul_f32 v[68:69], v[68:69], v[100:101]
  v_pk_mul_f32 v[70:71], v[70:71], v[102:103]
  v_cvt_pk_bf16_f32 v120, v56, v57
  v_cvt_pk_bf16_f32 v121, v58, v59
  v_cvt_pk_bf16_f32 v122, v60, v61
  v_cvt_pk_bf16_f32 v123, v62, v63
  v_cvt_pk_bf16_f32 v124, v64, v65
  v_cvt_pk_bf16_f32 v125, v66, v67
  v_cvt_pk_bf16_f32 v126, v68, v69
  v_cvt_pk_bf16_f32 v127, v70, v71
  s_mul_i32 s58, s60, 98304
  s_mul_i32 s59, s45, 12288
  s_add_u32 s58, s58, s59
  s_lshl_b32 s59, s48, 11
  s_add_u32 s58, s58, s59
  s_add_u32 s58, s58, 6295552
  buffer_store_dwordx4 v[120:123], v2, s[36:39], s58 offen sc1
  buffer_store_dwordx4 v[124:127], v2, s[36:39], s58 offen offset:1024 sc1
  s_barrier
  ds_read_b64_tr_b16 v[88:89], v7 offset:32768
  ds_read_b64_tr_b16 v[90:91], v7 offset:33792
  ds_read_b64_tr_b16 v[92:93], v7 offset:34816
  ds_read_b64_tr_b16 v[94:95], v7 offset:35840
  s_waitcnt lgkmcnt(2)
  v_mfma_f32_32x32x16_bf16 v[56:71], v[88:91], a[0:3], 0
  ds_read_b64_tr_b16 v[96:97], v7 offset:36864
  ds_read_b64_tr_b16 v[98:99], v7 offset:37888
  v_mfma_f32_16x16x32_bf16 v[112:115], v[28:31], v[88:91], 0
  s_waitcnt lgkmcnt(2)
  v_mfma_f32_32x32x16_bf16 v[56:71], v[92:95], a[4:7], v[56:71]
  ds_read_b64_tr_b16 v[88:89], v7 offset:38912
  ds_read_b64_tr_b16 v[90:91], v7 offset:39936
  v_mfma_f32_16x16x32_bf16 v[112:115], v[28:31], v[92:95], v[112:115]
  s_waitcnt lgkmcnt(2)
  v_mfma_f32_32x32x16_bf16 v[56:71], v[96:99], a[8:11], v[56:71]
  ds_read_b64_tr_b16 v[92:93], v7 offset:40960
  ds_read_b64_tr_b16 v[94:95], v7 offset:41984
  v_mfma_f32_16x16x32_bf16 v[112:115], v[28:31], v[96:99], v[112:115]
  s_waitcnt lgkmcnt(2)
  v_mfma_f32_32x32x16_bf16 v[56:71], v[88:91], a[12:15], v[56:71]
  ds_read_b64_tr_b16 v[96:97], v7 offset:43008
  ds_read_b64_tr_b16 v[98:99], v7 offset:44032
  v_mfma_f32_16x16x32_bf16 v[112:115], v[28:31], v[88:91], v[112:115]
  s_waitcnt lgkmcnt(2)
  v_mfma_f32_32x32x16_bf16 v[56:71], v[92:95], a[16:19], v[56:71]
  ds_read_b64_tr_b16 v[88:89], v7 offset:45056
  ds_read_b64_tr_b16 v[90:91], v7 offset:46080
  v_mfma_f32_16x16x32_bf16 v[112:115], v[28:31], v[92:95], v[112:115]
  s_waitcnt lgkmcnt(2)
  v_mfma_f32_32x32x16_bf16 v[56:71], v[96:99], a[20:23], v[56:71]
  ds_read_b64_tr_b16 v[92:93], v7 offset:47104
  ds_read_b64_tr_b16 v[94:95], v7 offset:48128
  v_mfma_f32_16x16x32_bf16 v[112:115], v[28:31], v[96:99], v[112:115]
  s_waitcnt lgkmcnt(2)
  v_mfma_f32_32x32x16_bf16 v[56:71], v[88:91], a[24:27], v[56:71]
  s_waitcnt lgkmcnt(0)
  s_barrier
  ds_read_b64_tr_b16 v[96:97], v6 offset:16384
  ds_read_b64_tr_b16 v[98:99], v6 offset:17408
  v_mfma_f32_16x16x32_bf16 v[112:115], v[28:31], v[88:91], v[112:115]
  v_mfma_f32_32x32x16_bf16 v[56:71], v[92:95], a[28:31], v[56:71]
  ds_read_b64_tr_b16 v[88:89], v6 offset:18432
  ds_read_b64_tr_b16 v[90:91], v6 offset:19456
  v_mfma_f32_16x16x32_bf16 v[112:115], v[28:31], v[92:95], v[112:115]
  s_waitcnt lgkmcnt(2)
  v_mfma_f32_32x32x16_bf16 v[56:71], v[96:99], a[32:35], v[56:71]
  ds_read_b64_tr_b16 v[92:93], v6 offset:20480
  ds_read_b64_tr_b16 v[94:95], v6 offset:21504
  v_mfma_f32_16x16x32_bf16 v[112:115], v[28:31], v[96:99], v[112:115]
  s_waitcnt lgkmcnt(2)
  v_mfma_f32_32x32x16_bf16 v[56:71], v[88:91], a[36:39], v[56:71]
  ds_read_b64_tr_b16 v[96:97], v6 offset:22528
  ds_read_b64_tr_b16 v[98:99], v6 offset:23552
  v_mfma_f32_16x16x32_bf16 v[112:115], v[28:31], v[88:91], v[112:115]
  s_waitcnt lgkmcnt(2)
  v_mfma_f32_32x32x16_bf16 v[56:71], v[92:95], a[40:43], v[56:71]
  ds_read_b64_tr_b16 v[88:89], v6 offset:24576
  ds_read_b64_tr_b16 v[90:91], v6 offset:25600
  v_mfma_f32_16x16x32_bf16 v[112:115], v[28:31], v[92:95], v[112:115]
  s_waitcnt lgkmcnt(2)
  v_mfma_f32_32x32x16_bf16 v[56:71], v[96:99], a[44:47], v[56:71]
  ds_read_b64_tr_b16 v[92:93], v6 offset:26624
  ds_read_b64_tr_b16 v[94:95], v6 offset:27648
  v_mfma_f32_16x16x32_bf16 v[112:115], v[28:31], v[96:99], v[112:115]
  s_waitcnt lgkmcnt(2)
  v_mfma_f32_32x32x16_bf16 v[56:71], v[88:91], a[48:51], v[56:71]
  ds_read_b64_tr_b16 v[96:97], v6 offset:28672
  ds_read_b64_tr_b16 v[98:99], v6 offset:29696
  v_mfma_f32_16x16x32_bf16 v[112:115], v[28:31], v[88:91], v[112:115]
  s_waitcnt lgkmcnt(2)
  v_mfma_f32_32x32x16_bf16 v[56:71], v[92:95], a[52:55], v[56:71]
  ds_read_b64_tr_b16 v[88:89], v6 offset:30720
  ds_read_b64_tr_b16 v[90:91], v6 offset:31744
  v_mfma_f32_16x16x32_bf16 v[112:115], v[28:31], v[92:95], v[112:115]
  s_waitcnt lgkmcnt(2)
  v_mfma_f32_32x32x16_bf16 v[56:71], v[96:99], a[56:59], v[56:71]
  s_waitcnt lgkmcnt(0)
  s_waitcnt vmcnt(2)
  s_barrier
  s_lshl_b32 s76, s83, 7
  s_lshl_b32 s77, s44, 2
  s_add_u32 s76, s76, s77
  s_add_u32 s76, s76, 12738560
  v_mov_b32 v13, 1
  buffer_store_dword v13, v14, s[36:39], s76 offen sc1
  ds_read_b64_tr_b16 v[92:93], v6 offset:32768
  ds_read_b64_tr_b16 v[94:95], v6 offset:33792
  v_mfma_f32_16x16x32_bf16 v[112:115], v[28:31], v[96:99], v[112:115]
  v_mfma_f32_32x32x16_bf16 v[56:71], v[88:91], a[60:63], v[56:71]
  ds_read_b64_tr_b16 v[96:97], v6 offset:34816
  ds_read_b64_tr_b16 v[98:99], v6 offset:35840
  v_mfma_f32_16x16x32_bf16 v[112:115], v[28:31], v[88:91], v[112:115]
  s_waitcnt lgkmcnt(2)
  v_mfma_f32_32x32x16_bf16 v[56:71], v[92:95], a[64:67], v[56:71]
  ds_read_b64_tr_b16 v[88:89], v6 offset:36864
  ds_read_b64_tr_b16 v[90:91], v6 offset:37888
  v_mfma_f32_16x16x32_bf16 v[112:115], v[28:31], v[92:95], v[112:115]
  s_waitcnt lgkmcnt(2)
  v_mfma_f32_32x32x16_bf16 v[56:71], v[96:99], a[68:71], v[56:71]
  ds_read_b64_tr_b16 v[92:93], v6 offset:38912
  ds_read_b64_tr_b16 v[94:95], v6 offset:39936
  v_mfma_f32_16x16x32_bf16 v[112:115], v[28:31], v[96:99], v[112:115]
  s_waitcnt lgkmcnt(2)
  v_mfma_f32_32x32x16_bf16 v[56:71], v[88:91], a[72:75], v[56:71]
  ds_read_b64_tr_b16 v[96:97], v6 offset:40960
  ds_read_b64_tr_b16 v[98:99], v6 offset:41984
  v_mfma_f32_16x16x32_bf16 v[112:115], v[28:31], v[88:91], v[112:115]
  s_waitcnt lgkmcnt(2)
  v_mfma_f32_32x32x16_bf16 v[56:71], v[92:95], a[76:79], v[56:71]
  ds_read_b64_tr_b16 v[88:89], v6 offset:43008
  ds_read_b64_tr_b16 v[90:91], v6 offset:44032
  v_mfma_f32_16x16x32_bf16 v[112:115], v[28:31], v[92:95], v[112:115]
  s_waitcnt lgkmcnt(2)
  v_mfma_f32_32x32x16_bf16 v[56:71], v[96:99], a[80:83], v[56:71]
  ds_read_b64_tr_b16 v[92:93], v6 offset:45056
  ds_read_b64_tr_b16 v[94:95], v6 offset:46080
  v_mfma_f32_16x16x32_bf16 v[112:115], v[28:31], v[96:99], v[112:115]
  s_waitcnt lgkmcnt(2)
  v_mfma_f32_32x32x16_bf16 v[56:71], v[88:91], a[84:87], v[56:71]
  ds_read_b64_tr_b16 v[96:97], v6 offset:47104
  ds_read_b64_tr_b16 v[98:99], v6 offset:48128
  v_mfma_f32_16x16x32_bf16 v[112:115], v[28:31], v[88:91], v[112:115]
  s_waitcnt lgkmcnt(2)
  v_mfma_f32_32x32x16_bf16 v[56:71], v[92:95], a[88:91], v[56:71]
  s_waitcnt lgkmcnt(0)
  s_waitcnt vmcnt(1)
  s_barrier
  s_lshl_b32 s76, s44, 7
  s_lshl_b32 s77, s45, 2
  s_add_u32 s76, s76, s77
  s_add_u32 s76, s76, 12730368
  v_mov_b32 v13, 1
  buffer_store_dword v13, v14, s[36:39], s76 offen sc1
  ds_read_b64_tr_b16 v[88:89], v6 offset:49152
  ds_read_b64_tr_b16 v[90:91], v6 offset:50176
  v_mfma_f32_16x16x32_bf16 v[112:115], v[28:31], v[92:95], v[112:115]
  v_mfma_f32_32x32x16_bf16 v[56:71], v[96:99], a[92:95], v[56:71]
  ds_read_b64_tr_b16 v[92:93], v6 offset:51200
  ds_read_b64_tr_b16 v[94:95], v6 offset:52224
  v_mfma_f32_16x16x32_bf16 v[112:115], v[28:31], v[96:99], v[112:115]
  s_waitcnt lgkmcnt(2)
  v_mfma_f32_32x32x16_bf16 v[56:71], v[88:91], a[96:99], v[56:71]
  ds_read_b64_tr_b16 v[96:97], v6 offset:53248
  ds_read_b64_tr_b16 v[98:99], v6 offset:54272
  v_mfma_f32_16x16x32_bf16 v[112:115], v[28:31], v[88:91], v[112:115]
  s_waitcnt lgkmcnt(2)
  v_mfma_f32_32x32x16_bf16 v[56:71], v[92:95], a[100:103], v[56:71]
  ds_read_b64_tr_b16 v[88:89], v6 offset:55296
  ds_read_b64_tr_b16 v[90:91], v6 offset:56320
  v_mfma_f32_16x16x32_bf16 v[112:115], v[28:31], v[92:95], v[112:115]
  s_waitcnt lgkmcnt(2)
  v_mfma_f32_32x32x16_bf16 v[56:71], v[96:99], a[104:107], v[56:71]
  ds_read_b64_tr_b16 v[92:93], v6 offset:57344
  ds_read_b64_tr_b16 v[94:95], v6 offset:58368
  v_mfma_f32_16x16x32_bf16 v[112:115], v[28:31], v[96:99], v[112:115]
  s_waitcnt lgkmcnt(2)
  v_mfma_f32_32x32x16_bf16 v[56:71], v[88:91], a[108:111], v[56:71]
  ds_read_b64_tr_b16 v[96:97], v6 offset:59392
  ds_read_b64_tr_b16 v[98:99], v6 offset:60416
  v_mfma_f32_16x16x32_bf16 v[112:115], v[28:31], v[88:91], v[112:115]
  s_waitcnt lgkmcnt(2)
  v_mfma_f32_32x32x16_bf16 v[56:71], v[92:95], a[112:115], v[56:71]
  ds_read_b64_tr_b16 v[88:89], v6 offset:61440
  ds_read_b64_tr_b16 v[90:91], v6 offset:62464
  v_mfma_f32_16x16x32_bf16 v[112:115], v[28:31], v[92:95], v[112:115]
  s_waitcnt lgkmcnt(2)
  v_mfma_f32_32x32x16_bf16 v[56:71], v[96:99], a[116:119], v[56:71]
  ds_read_b64_tr_b16 v[92:93], v6 offset:63488
  ds_read_b64_tr_b16 v[94:95], v6 offset:64512
  v_mfma_f32_16x16x32_bf16 v[112:115], v[28:31], v[96:99], v[112:115]
  s_waitcnt lgkmcnt(2)
  v_mfma_f32_32x32x16_bf16 v[56:71], v[88:91], a[120:123], v[56:71]
  v_mfma_f32_16x16x32_bf16 v[112:115], v[28:31], v[88:91], v[112:115]
  s_waitcnt lgkmcnt(0)
  v_mfma_f32_32x32x16_bf16 v[56:71], v[92:95], a[124:127], v[56:71]
  v_mfma_f32_16x16x32_bf16 v[112:115], v[28:31], v[92:95], v[112:115]
  s_barrier
  s_nop 10
  v_fmac_f32_dpp v56, v112, v21 row_newbcast:0 row_mask:0x3 bank_mask:0xf
  v_fmac_f32_dpp v56, v112, v21 row_newbcast:4 row_mask:0xc bank_mask:0xf
  v_fmac_f32_dpp v57, v112, v21 row_newbcast:1 row_mask:0x3 bank_mask:0xf
  v_fmac_f32_dpp v57, v112, v21 row_newbcast:5 row_mask:0xc bank_mask:0xf
  v_fmac_f32_dpp v58, v112, v21 row_newbcast:2 row_mask:0x3 bank_mask:0xf
  v_fmac_f32_dpp v58, v112, v21 row_newbcast:6 row_mask:0xc bank_mask:0xf
  v_fmac_f32_dpp v59, v112, v21 row_newbcast:3 row_mask:0x3 bank_mask:0xf
  v_fmac_f32_dpp v59, v112, v21 row_newbcast:7 row_mask:0xc bank_mask:0xf
  v_fmac_f32_dpp v60, v112, v21 row_newbcast:8 row_mask:0x3 bank_mask:0xf
  v_fmac_f32_dpp v60, v112, v21 row_newbcast:12 row_mask:0xc bank_mask:0xf
  v_fmac_f32_dpp v61, v112, v21 row_newbcast:9 row_mask:0x3 bank_mask:0xf
  v_fmac_f32_dpp v61, v112, v21 row_newbcast:13 row_mask:0xc bank_mask:0xf
  v_fmac_f32_dpp v62, v112, v21 row_newbcast:10 row_mask:0x3 bank_mask:0xf
  v_fmac_f32_dpp v62, v112, v21 row_newbcast:14 row_mask:0xc bank_mask:0xf
  v_fmac_f32_dpp v63, v112, v21 row_newbcast:11 row_mask:0x3 bank_mask:0xf
  v_fmac_f32_dpp v63, v112, v21 row_newbcast:15 row_mask:0xc bank_mask:0xf
  v_fmac_f32_dpp v64, v113, v21 row_newbcast:0 row_mask:0x3 bank_mask:0xf
  v_fmac_f32_dpp v64, v113, v21 row_newbcast:4 row_mask:0xc bank_mask:0xf
  v_fmac_f32_dpp v65, v113, v21 row_newbcast:1 row_mask:0x3 bank_mask:0xf
  v_fmac_f32_dpp v65, v113, v21 row_newbcast:5 row_mask:0xc bank_mask:0xf
  v_fmac_f32_dpp v66, v113, v21 row_newbcast:2 row_mask:0x3 bank_mask:0xf
  v_fmac_f32_dpp v66, v113, v21 row_newbcast:6 row_mask:0xc bank_mask:0xf
  v_fmac_f32_dpp v67, v113, v21 row_newbcast:3 row_mask:0x3 bank_mask:0xf
  v_fmac_f32_dpp v67, v113, v21 row_newbcast:7 row_mask:0xc bank_mask:0xf
  v_fmac_f32_dpp v68, v113, v21 row_newbcast:8 row_mask:0x3 bank_mask:0xf
  v_fmac_f32_dpp v68, v113, v21 row_newbcast:12 row_mask:0xc bank_mask:0xf
  v_fmac_f32_dpp v69, v113, v21 row_newbcast:9 row_mask:0x3 bank_mask:0xf
  v_fmac_f32_dpp v69, v113, v21 row_newbcast:13 row_mask:0xc bank_mask:0xf
  v_fmac_f32_dpp v70, v113, v21 row_newbcast:10 row_mask:0x3 bank_mask:0xf
  v_fmac_f32_dpp v70, v113, v21 row_newbcast:14 row_mask:0xc bank_mask:0xf
  v_fmac_f32_dpp v71, v113, v21 row_newbcast:11 row_mask:0x3 bank_mask:0xf
  v_fmac_f32_dpp v71, v113, v21 row_newbcast:15 row_mask:0xc bank_mask:0xf
  v_pk_mul_f32 v[56:57], v[56:57], v[24:25] op_sel_hi:[1,0]
  v_pk_mul_f32 v[58:59], v[58:59], v[24:25] op_sel_hi:[1,0]
  v_pk_mul_f32 v[60:61], v[60:61], v[24:25] op_sel_hi:[1,0]
  v_pk_mul_f32 v[62:63], v[62:63], v[24:25] op_sel_hi:[1,0]
  v_pk_mul_f32 v[64:65], v[64:65], v[24:25] op_sel_hi:[1,0]
  v_pk_mul_f32 v[66:67], v[66:67], v[24:25] op_sel_hi:[1,0]
  v_pk_mul_f32 v[68:69], v[68:69], v[24:25] op_sel_hi:[1,0]
  v_pk_mul_f32 v[70:71], v[70:71], v[24:25] op_sel_hi:[1,0]
  v_pk_mul_f32 v[88:89], v[56:57], v[56:57]
  v_pk_mul_f32 v[90:91], v[58:59], v[58:59]
  v_pk_mul_f32 v[92:93], v[60:61], v[60:61]
  v_pk_mul_f32 v[94:95], v[62:63], v[62:63]
  v_pk_mul_f32 v[96:97], v[64:65], v[64:65]
  v_pk_mul_f32 v[98:99], v[66:67], v[66:67]
  v_pk_mul_f32 v[100:101], v[68:69], v[68:69]
  v_pk_mul_f32 v[102:103], v[70:71], v[70:71]
  v_pk_fma_f32 v[88:89], v[88:89], s[64:65], v[26:27]
  v_pk_fma_f32 v[90:91], v[90:91], s[64:65], v[26:27]
  v_pk_fma_f32 v[92:93], v[92:93], s[64:65], v[26:27]
  v_pk_fma_f32 v[94:95], v[94:95], s[64:65], v[26:27]
  v_pk_fma_f32 v[96:97], v[96:97], s[64:65], v[26:27]
  v_pk_fma_f32 v[98:99], v[98:99], s[64:65], v[26:27]
  v_pk_fma_f32 v[100:101], v[100:101], s[64:65], v[26:27]
  v_pk_fma_f32 v[102:103], v[102:103], s[64:65], v[26:27]
  v_pk_mul_f32 v[88:89], v[88:89], v[56:57]
  v_pk_mul_f32 v[90:91], v[90:91], v[58:59]
  v_pk_mul_f32 v[92:93], v[92:93], v[60:61]
  v_pk_mul_f32 v[94:95], v[94:95], v[62:63]
  v_pk_mul_f32 v[96:97], v[96:97], v[64:65]
  v_pk_mul_f32 v[98:99], v[98:99], v[66:67]
  v_pk_mul_f32 v[100:101], v[100:101], v[68:69]
  v_pk_mul_f32 v[102:103], v[102:103], v[70:71]
  v_exp_f32 v88, v88
  v_exp_f32 v89, v89
  v_exp_f32 v90, v90
  v_exp_f32 v91, v91
  v_exp_f32 v92, v92
  v_exp_f32 v93, v93
  v_exp_f32 v94, v94
  v_exp_f32 v95, v95
  v_exp_f32 v96, v96
  v_exp_f32 v97, v97
  v_exp_f32 v98, v98
  v_exp_f32 v99, v99
  v_exp_f32 v100, v100
  v_exp_f32 v101, v101
  v_exp_f32 v102, v102
  v_exp_f32 v103, v103
  v_pk_add_f32 v[88:89], v[88:89], s[66:67]
  v_pk_add_f32 v[90:91], v[90:91], s[66:67]
  v_pk_add_f32 v[92:93], v[92:93], s[66:67]
  v_pk_add_f32 v[94:95], v[94:95], s[66:67]
  v_pk_add_f32 v[96:97], v[96:97], s[66:67]
  v_pk_add_f32 v[98:99], v[98:99], s[66:67]
  v_pk_add_f32 v[100:101], v[100:101], s[66:67]
  v_pk_add_f32 v[102:103], v[102:103], s[66:67]
  v_rcp_f32 v88, v88
  v_rcp_f32 v89, v89
  v_rcp_f32 v90, v90
  v_rcp_f32 v91, v91
  v_rcp_f32 v92, v92
  v_rcp_f32 v93, v93
  v_rcp_f32 v94, v94
  v_rcp_f32 v95, v95
  v_rcp_f32 v96, v96
  v_rcp_f32 v97, v97
  v_rcp_f32 v98, v98
  v_rcp_f32 v99, v99
  v_rcp_f32 v100, v100
  v_rcp_f32 v101, v101
  v_rcp_f32 v102, v102
  v_rcp_f32 v103, v103
  v_pk_mul_f32 v[56:57], v[56:57], v[88:89]
  v_pk_mul_f32 v[58:59], v[58:59], v[90:91]
  v_pk_mul_f32 v[60:61], v[60:61], v[92:93]
  v_pk_mul_f32 v[62:63], v[62:63], v[94:95]
  v_pk_mul_f32 v[64:65], v[64:65], v[96:97]
  v_pk_mul_f32 v[66:67], v[66:67], v[98:99]
  v_pk_mul_f32 v[68:69], v[68:69], v[100:101]
  v_pk_mul_f32 v[70:71], v[70:71], v[102:103]
  v_cvt_pk_bf16_f32 v120, v56, v57
  v_cvt_pk_bf16_f32 v121, v58, v59
  v_cvt_pk_bf16_f32 v122, v60, v61
  v_cvt_pk_bf16_f32 v123, v62, v63
  v_cvt_pk_bf16_f32 v124, v64, v65
  v_cvt_pk_bf16_f32 v125, v66, v67
  v_cvt_pk_bf16_f32 v126, v68, v69
  v_cvt_pk_bf16_f32 v127, v70, v71
  s_mul_i32 s58, s60, 98304
  s_mul_i32 s59, s45, 12288
  s_add_u32 s58, s58, s59
  s_lshl_b32 s59, s48, 11
  s_add_u32 s58, s58, s59
  s_add_u32 s58, s58, 6299648
  buffer_store_dwordx4 v[120:123], v2, s[36:39], s58 offen sc1
  buffer_store_dwordx4 v[124:127], v2, s[36:39], s58 offen offset:1024 sc1
  s_barrier
  ds_read_b128 v[100:103], v10 offset:0
  ds_read_b64_tr_b16 v[88:89], v7 offset:49152
  ds_read_b64_tr_b16 v[90:91], v7 offset:50176
  ds_read_b128 v[104:107], v10 offset:1024
  ds_read_b64_tr_b16 v[92:93], v7 offset:51200
  ds_read_b64_tr_b16 v[94:95], v7 offset:52224
  s_waitcnt lgkmcnt(3)
  v_mfma_f32_32x32x16_bf16 v[72:87], v[88:91], v[100:103], 0
  ds_read_b128 v[108:111], v10 offset:2048
  ds_read_b64_tr_b16 v[96:97], v7 offset:53248
  ds_read_b64_tr_b16 v[98:99], v7 offset:54272
  s_waitcnt lgkmcnt(3)
  v_mfma_f32_32x32x16_bf16 v[72:87], v[92:95], v[104:107], v[72:87]
  ds_read_b128 v[100:103], v10 offset:3072
  ds_read_b64_tr_b16 v[88:89], v7 offset:55296
  ds_read_b64_tr_b16 v[90:91], v7 offset:56320
  s_waitcnt lgkmcnt(3)
  v_mfma_f32_32x32x16_bf16 v[72:87], v[96:99], v[108:111], v[72:87]
  ds_read_b128 v[104:107], v10 offset:4096
  ds_read_b64_tr_b16 v[92:93], v7 offset:57344
  ds_read_b64_tr_b16 v[94:95], v7 offset:58368
  s_waitcnt lgkmcnt(3)
  v_mfma_f32_32x32x16_bf16 v[72:87], v[88:91], v[100:103], v[72:87]
  ds_read_b128 v[108:111], v10 offset:5120
  ds_read_b64_tr_b16 v[96:97], v7 offset:59392
  ds_read_b64_tr_b16 v[98:99], v7 offset:60416
  s_waitcnt lgkmcnt(3)
  v_mfma_f32_32x32x16_bf16 v[72:87], v[92:95], v[104:107], v[72:87]
  ds_read_b128 v[100:103], v10 offset:6144
  ds_read_b64_tr_b16 v[88:89], v7 offset:61440
  ds_read_b64_tr_b16 v[90:91], v7 offset:62464
  s_waitcnt lgkmcnt(3)
  v_mfma_f32_32x32x16_bf16 v[72:87], v[96:99], v[108:111], v[72:87]
  ds_read_b128 v[104:107], v10 offset:7168
  ds_read_b64_tr_b16 v[92:93], v7 offset:63488
  ds_read_b64_tr_b16 v[94:95], v7 offset:64512
  s_waitcnt lgkmcnt(3)
  v_mfma_f32_32x32x16_bf16 v[72:87], v[88:91], v[100:103], v[72:87]
  s_waitcnt lgkmcnt(0)
  s_waitcnt vmcnt(0)
  s_barrier
  s_lshl_b32 s76, s44, 7
  s_lshl_b32 s77, s45, 2
  s_add_u32 s76, s76, s77
  s_add_u32 s76, s76, 12734464
  v_mov_b32 v13, 1
  buffer_store_dword v13, v14, s[36:39], s76 offen sc1
  ds_read_b128 v[108:111], v10 offset:16384
  ds_read_b64_tr_b16 v[96:97], v8 offset:0
  ds_read_b64_tr_b16 v[98:99], v8 offset:1024
  v_mfma_f32_32x32x16_bf16 v[72:87], v[92:95], v[104:107], v[72:87]
  ds_read_b128 v[100:103], v10 offset:17408
  ds_read_b64_tr_b16 v[88:89], v8 offset:2048
  ds_read_b64_tr_b16 v[90:91], v8 offset:3072
  s_waitcnt lgkmcnt(3)
  v_mfma_f32_32x32x16_bf16 v[72:87], v[96:99], v[108:111], v[72:87]
  ds_read_b128 v[104:107], v10 offset:18432
  ds_read_b64_tr_b16 v[92:93], v8 offset:4096
  ds_read_b64_tr_b16 v[94:95], v8 offset:5120
  s_waitcnt lgkmcnt(3)
  v_mfma_f32_32x32x16_bf16 v[72:87], v[88:91], v[100:103], v[72:87]
  ds_read_b128 v[108:111], v10 offset:19456
  ds_read_b64_tr_b16 v[96:97], v8 offset:6144
  ds_read_b64_tr_b16 v[98:99], v8 offset:7168
  s_waitcnt lgkmcnt(3)
  v_mfma_f32_32x32x16_bf16 v[72:87], v[92:95], v[104:107], v[72:87]
  ds_read_b128 v[100:103], v10 offset:20480
  ds_read_b64_tr_b16 v[88:89], v8 offset:8192
  ds_read_b64_tr_b16 v[90:91], v8 offset:9216
  s_waitcnt lgkmcnt(3)
  v_mfma_f32_32x32x16_bf16 v[72:87], v[96:99], v[108:111], v[72:87]
  ds_read_b128 v[104:107], v10 offset:21504
  ds_read_b64_tr_b16 v[92:93], v8 offset:10240
  ds_read_b64_tr_b16 v[94:95], v8 offset:11264
  s_waitcnt lgkmcnt(3)
  v_mfma_f32_32x32x16_bf16 v[72:87], v[88:91], v[100:103], v[72:87]
  ds_read_b128 v[108:111], v10 offset:22528
  ds_read_b64_tr_b16 v[96:97], v8 offset:12288
  ds_read_b64_tr_b16 v[98:99], v8 offset:13312
  s_waitcnt lgkmcnt(3)
  v_mfma_f32_32x32x16_bf16 v[72:87], v[92:95], v[104:107], v[72:87]
  ds_read_b128 v[100:103], v10 offset:23552
  ds_read_b64_tr_b16 v[88:89], v8 offset:14336
  ds_read_b64_tr_b16 v[90:91], v8 offset:15360
  s_waitcnt lgkmcnt(3)
  v_mfma_f32_32x32x16_bf16 v[72:87], v[96:99], v[108:111], v[72:87]
  s_waitcnt lgkmcnt(0)
  s_barrier
  ds_read_b128 v[104:107], v10 offset:32768
  ds_read_b64_tr_b16 v[92:93], v6 offset:0
  ds_read_b64_tr_b16 v[94:95], v6 offset:1024
  v_mfma_f32_32x32x16_bf16 v[72:87], v[88:91], v[100:103], v[72:87]
  ds_read_b128 v[108:111], v10 offset:33792
  ds_read_b64_tr_b16 v[96:97], v6 offset:2048
  ds_read_b64_tr_b16 v[98:99], v6 offset:3072
  s_waitcnt lgkmcnt(3)
  v_mfma_f32_32x32x16_bf16 v[72:87], v[92:95], v[104:107], v[72:87]
  ds_read_b128 v[100:103], v10 offset:34816
  ds_read_b64_tr_b16 v[88:89], v6 offset:4096
  ds_read_b64_tr_b16 v[90:91], v6 offset:5120
  s_waitcnt lgkmcnt(3)
  v_mfma_f32_32x32x16_bf16 v[72:87], v[96:99], v[108:111], v[72:87]
  ds_read_b128 v[104:107], v10 offset:35840
  ds_read_b64_tr_b16 v[92:93], v6 offset:6144
  ds_read_b64_tr_b16 v[94:95], v6 offset:7168
  s_waitcnt lgkmcnt(3)
  v_mfma_f32_32x32x16_bf16 v[72:87], v[88:91], v[100:103], v[72:87]
  ds_read_b128 v[108:111], v10 offset:36864
  ds_read_b64_tr_b16 v[96:97], v6 offset:8192
  ds_read_b64_tr_b16 v[98:99], v6 offset:9216
  s_waitcnt lgkmcnt(3)
  v_mfma_f32_32x32x16_bf16 v[72:87], v[92:95], v[104:107], v[72:87]
  ds_read_b128 v[100:103], v10 offset:37888
  ds_read_b64_tr_b16 v[88:89], v6 offset:10240
  ds_read_b64_tr_b16 v[90:91], v6 offset:11264
  s_waitcnt lgkmcnt(3)
  v_mfma_f32_32x32x16_bf16 v[72:87], v[96:99], v[108:111], v[72:87]
  ds_read_b128 v[104:107], v10 offset:38912
  ds_read_b64_tr_b16 v[92:93], v6 offset:12288
  ds_read_b64_tr_b16 v[94:95], v6 offset:13312
  s_waitcnt lgkmcnt(3)
  v_mfma_f32_32x32x16_bf16 v[72:87], v[88:91], v[100:103], v[72:87]
  ds_read_b128 v[108:111], v10 offset:39936
  ds_read_b64_tr_b16 v[96:97], v6 offset:14336
  ds_read_b64_tr_b16 v[98:99], v6 offset:15360
  s_waitcnt lgkmcnt(3)
  v_mfma_f32_32x32x16_bf16 v[72:87], v[92:95], v[104:107], v[72:87]
  s_waitcnt lgkmcnt(0)
  s_barrier
  ds_read_b128 v[100:103], v9 offset:32768
  ds_read_b64_tr_b16 v[88:89], v6 offset:16384
  ds_read_b64_tr_b16 v[90:91], v6 offset:17408
  v_mfma_f32_32x32x16_bf16 v[72:87], v[96:99], v[108:111], v[72:87]
  ds_read_b128 v[104:107], v9 offset:33792
  ds_read_b64_tr_b16 v[92:93], v6 offset:18432
  ds_read_b64_tr_b16 v[94:95], v6 offset:19456
  s_waitcnt lgkmcnt(3)
  v_mfma_f32_32x32x16_bf16 v[72:87], v[88:91], v[100:103], v[72:87]
  ds_read_b128 v[108:111], v9 offset:34816
  ds_read_b64_tr_b16 v[96:97], v6 offset:20480
  ds_read_b64_tr_b16 v[98:99], v6 offset:21504
  s_waitcnt lgkmcnt(3)
  v_mfma_f32_32x32x16_bf16 v[72:87], v[92:95], v[104:107], v[72:87]
  ds_read_b128 v[100:103], v9 offset:35840
  ds_read_b64_tr_b16 v[88:89], v6 offset:22528
  ds_read_b64_tr_b16 v[90:91], v6 offset:23552
  s_waitcnt lgkmcnt(3)
  v_mfma_f32_32x32x16_bf16 v[72:87], v[96:99], v[108:111], v[72:87]
  ds_read_b128 v[104:107], v9 offset:36864
  ds_read_b64_tr_b16 v[92:93], v6 offset:24576
  ds_read_b64_tr_b16 v[94:95], v6 offset:25600
  s_waitcnt lgkmcnt(3)
  v_mfma_f32_32x32x16_bf16 v[72:87], v[88:91], v[100:103], v[72:87]
  ds_read_b128 v[108:111], v9 offset:37888
  ds_read_b64_tr_b16 v[96:97], v6 offset:26624
  ds_read_b64_tr_b16 v[98:99], v6 offset:27648
  s_waitcnt lgkmcnt(3)
  v_mfma_f32_32x32x16_bf16 v[72:87], v[92:95], v[104:107], v[72:87]
  s_waitcnt lgkmcnt(0)
  v_mfma_f32_32x32x16_bf16 v[72:87], v[96:99], v[108:111], v[72:87]
  s_barrier
  s_mul_i32 s58, s48, 3072
  s_add_u32 s58, s58, 149504
  v_lshl_add_u32 v13, v1, 2, s58
  v_bfe_u32 v16, v1, 4, 1
  v_lshlrev_b32 v16, 6, v16
  v_lshrrev_b32 v12, 5, v1
  v_lshl_add_u32 v16, v12, 4, v16
  v_add_u32 v16, s58, v16
  ds_read_b32 v56, v13 offset:0
  ds_read_b32 v57, v13 offset:256
  ds_read_b32 v58, v13 offset:512
  ds_read_b32 v59, v13 offset:768
  ds_read_b32 v60, v13 offset:1024
  ds_read_b32 v61, v13 offset:1280
  ds_read_b32 v62, v13 offset:1536
  ds_read_b32 v63, v13 offset:1792
  ds_read_b128 v[64:67], v16 offset:2048
  ds_read_b128 v[68:71], v16 offset:2080
  v_mov_b32 v13, 0
  s_waitcnt lgkmcnt(0)
  v_cvt_pk_bf16_f32 v120, v56, v57
  v_cvt_pk_bf16_f32 v124, v64, v65
  v_cvt_pk_bf16_f32 v121, v58, v59
  v_cvt_pk_bf16_f32 v125, v66, v67
  v_cvt_pk_bf16_f32 v122, v60, v61
  v_cvt_pk_bf16_f32 v126, v68, v69
  v_cvt_pk_bf16_f32 v123, v62, v63
  v_cvt_pk_bf16_f32 v127, v70, v71
  v_cndmask_b32 v104, v120, v13, s[62:63]
  v_cndmask_b32 v112, v13, v120, s[62:63]
  v_cndmask_b32 v105, v121, v13, s[62:63]
  v_cndmask_b32 v113, v13, v121, s[62:63]
  v_cndmask_b32 v106, v122, v13, s[62:63]
  v_cndmask_b32 v114, v13, v122, s[62:63]
  v_cndmask_b32 v107, v123, v13, s[62:63]
  v_cndmask_b32 v115, v13, v123, s[62:63]
  v_cndmask_b32 v108, v124, v13, s[62:63]
  v_cndmask_b32 v116, v13, v124, s[62:63]
  v_cndmask_b32 v109, v125, v13, s[62:63]
  v_cndmask_b32 v117, v13, v125, s[62:63]
  v_cndmask_b32 v110, v126, v13, s[62:63]
  v_cndmask_b32 v118, v13, v126, s[62:63]
  v_cndmask_b32 v111, v127, v13, s[62:63]
  v_cndmask_b32 v119, v13, v127, s[62:63]
  s_nop 1
  v_mfma_f32_32x32x16_bf16 v[56:71], v[104:107], v[48:51], 0
  v_mfma_f32_32x32x16_bf16 v[88:103], v[108:111], v[48:51], 0
  v_mfma_f32_32x32x16_bf16 v[56:71], v[112:115], v[52:55], v[56:71]
  v_mfma_f32_32x32x16_bf16 v[88:103], v[116:119], v[52:55], v[88:103]
  s_nop 15
  v_add_f32 v120, 0x358637bd, v88
  v_add_f32 v122, 0x358637bd, v96
  v_rcp_f32 v120, v120
  v_rcp_f32 v122, v122
  s_nop 0
  v_pk_mul_f32 v[56:57], v[56:57], v[120:121] op_sel_hi:[1,0]
  v_pk_mul_f32 v[58:59], v[58:59], v[120:121] op_sel_hi:[1,0]
  v_pk_mul_f32 v[60:61], v[60:61], v[120:121] op_sel_hi:[1,0]
  v_pk_mul_f32 v[62:63], v[62:63], v[120:121] op_sel_hi:[1,0]
  v_pk_mul_f32 v[64:65], v[64:65], v[122:123] op_sel_hi:[1,0]
  v_pk_mul_f32 v[66:67], v[66:67], v[122:123] op_sel_hi:[1,0]
  v_pk_mul_f32 v[68:69], v[68:69], v[122:123] op_sel_hi:[1,0]
  v_pk_mul_f32 v[70:71], v[70:71], v[122:123] op_sel_hi:[1,0]
  v_cvt_pk_bf16_f32 v48, v56, v57
  v_cvt_pk_bf16_f32 v49, v58, v59
  v_cvt_pk_bf16_f32 v50, v60, v61
  v_cvt_pk_bf16_f32 v51, v62, v63
  v_cvt_pk_bf16_f32 v52, v64, v65
  v_cvt_pk_bf16_f32 v53, v66, v67
  v_cvt_pk_bf16_f32 v54, v68, v69
  v_cvt_pk_bf16_f32 v55, v70, v71
  s_mul_i32 s58, s60, 32768
  s_mul_i32 s59, s83, 4096
  s_add_u32 s58, s58, s59
  s_lshl_b32 s59, s48, 11
  s_add_u32 s58, s58, s59
  s_add_u32 s58, s58, 4194304
  buffer_store_dwordx4 v[48:51], v2, s[36:39], s58 offen sc1
  buffer_store_dwordx4 v[52:55], v2, s[36:39], s58 offen offset:1024 sc1
  s_barrier
  ds_read_b128 v[100:103], v10 offset:49152
  ds_read_b64_tr_b16 v[88:89], v6 offset:49152
  ds_read_b64_tr_b16 v[90:91], v6 offset:50176
  ds_read_b128 v[104:107], v10 offset:50176
  ds_read_b64_tr_b16 v[92:93], v6 offset:51200
  ds_read_b64_tr_b16 v[94:95], v6 offset:52224
  s_waitcnt lgkmcnt(3)
  v_mfma_f32_32x32x16_bf16 v[72:87], v[88:91], v[100:103], v[72:87]
  ds_read_b128 v[108:111], v10 offset:51200
  ds_read_b64_tr_b16 v[96:97], v6 offset:53248
  ds_read_b64_tr_b16 v[98:99], v6 offset:54272
  s_waitcnt lgkmcnt(3)
  v_mfma_f32_32x32x16_bf16 v[72:87], v[92:95], v[104:107], v[72:87]
  ds_read_b128 v[100:103], v10 offset:52224
  ds_read_b64_tr_b16 v[88:89], v6 offset:55296
  ds_read_b64_tr_b16 v[90:91], v6 offset:56320
  s_waitcnt lgkmcnt(3)
  v_mfma_f32_32x32x16_bf16 v[72:87], v[96:99], v[108:111], v[72:87]
  ds_read_b128 v[104:107], v10 offset:53248
  ds_read_b64_tr_b16 v[92:93], v6 offset:57344
  ds_read_b64_tr_b16 v[94:95], v6 offset:58368
  s_waitcnt lgkmcnt(3)
  v_mfma_f32_32x32x16_bf16 v[72:87], v[88:91], v[100:103], v[72:87]
  ds_read_b128 v[108:111], v10 offset:54272
  ds_read_b64_tr_b16 v[96:97], v6 offset:59392
  ds_read_b64_tr_b16 v[98:99], v6 offset:60416
  s_waitcnt lgkmcnt(3)
  v_mfma_f32_32x32x16_bf16 v[72:87], v[92:95], v[104:107], v[72:87]
  ds_read_b128 v[100:103], v10 offset:55296
  ds_read_b64_tr_b16 v[88:89], v6 offset:61440
  ds_read_b64_tr_b16 v[90:91], v6 offset:62464
  s_waitcnt lgkmcnt(3)
  v_mfma_f32_32x32x16_bf16 v[72:87], v[96:99], v[108:111], v[72:87]
  ds_read_b128 v[104:107], v10 offset:56320
  ds_read_b64_tr_b16 v[92:93], v6 offset:63488
  ds_read_b64_tr_b16 v[94:95], v6 offset:64512
  s_waitcnt lgkmcnt(3)
  v_mfma_f32_32x32x16_bf16 v[72:87], v[88:91], v[100:103], v[72:87]
  s_waitcnt lgkmcnt(0)
  s_waitcnt vmcnt(0)
  s_barrier
  s_lshl_b32 s76, s44, 7
  s_lshl_b32 s77, s45, 2
  s_add_u32 s76, s76, s77
  s_add_u32 s76, s76, 12722176
  v_mov_b32 v13, 1
  buffer_store_dword v13, v14, s[36:39], s76 offen sc1
  ds_read_b128 v[108:111], v11 offset:0
  ds_read_b64_tr_b16 v[96:97], v7 offset:0
  ds_read_b64_tr_b16 v[98:99], v7 offset:1024
  v_mfma_f32_32x32x16_bf16 v[72:87], v[92:95], v[104:107], v[72:87]
  ds_read_b128 v[100:103], v11 offset:1024
  ds_read_b64_tr_b16 v[88:89], v7 offset:2048
  ds_read_b64_tr_b16 v[90:91], v7 offset:3072
  s_waitcnt lgkmcnt(3)
  v_mfma_f32_32x32x16_bf16 v[72:87], v[96:99], v[108:111], v[72:87]
  ds_read_b128 v[104:107], v11 offset:2048
  ds_read_b64_tr_b16 v[92:93], v7 offset:4096
  ds_read_b64_tr_b16 v[94:95], v7 offset:5120
  s_waitcnt lgkmcnt(3)
  v_mfma_f32_32x32x16_bf16 v[72:87], v[88:91], v[100:103], v[72:87]
  ds_read_b128 v[108:111], v11 offset:3072
  ds_read_b64_tr_b16 v[96:97], v7 offset:6144
  ds_read_b64_tr_b16 v[98:99], v7 offset:7168
  s_waitcnt lgkmcnt(3)
  v_mfma_f32_32x32x16_bf16 v[72:87], v[92:95], v[104:107], v[72:87]
  ds_read_b128 v[100:103], v11 offset:4096
  ds_read_b64_tr_b16 v[88:89], v7 offset:8192
  ds_read_b64_tr_b16 v[90:91], v7 offset:9216
  s_waitcnt lgkmcnt(3)
  v_mfma_f32_32x32x16_bf16 v[72:87], v[96:99], v[108:111], v[72:87]
  ds_read_b128 v[104:107], v11 offset:5120
  ds_read_b64_tr_b16 v[92:93], v7 offset:10240
  ds_read_b64_tr_b16 v[94:95], v7 offset:11264
  s_waitcnt lgkmcnt(3)
  v_mfma_f32_32x32x16_bf16 v[72:87], v[88:91], v[100:103], v[72:87]
  ds_read_b128 v[108:111], v11 offset:6144
  ds_read_b64_tr_b16 v[96:97], v7 offset:12288
  ds_read_b64_tr_b16 v[98:99], v7 offset:13312
  s_waitcnt lgkmcnt(3)
  v_mfma_f32_32x32x16_bf16 v[72:87], v[92:95], v[104:107], v[72:87]
  ds_read_b128 v[100:103], v11 offset:7168
  ds_read_b64_tr_b16 v[88:89], v7 offset:14336
  ds_read_b64_tr_b16 v[90:91], v7 offset:15360
  s_waitcnt lgkmcnt(3)
  v_mfma_f32_32x32x16_bf16 v[72:87], v[96:99], v[108:111], v[72:87]
  s_waitcnt lgkmcnt(0)
  s_barrier
  ds_read_b128 v[104:107], v9 offset:0
  ds_read_b64_tr_b16 v[92:93], v7 offset:16384
  ds_read_b64_tr_b16 v[94:95], v7 offset:17408
  v_mfma_f32_32x32x16_bf16 v[72:87], v[88:91], v[100:103], v[72:87]
  ds_read_b128 v[108:111], v9 offset:1024
  ds_read_b64_tr_b16 v[96:97], v7 offset:18432
  ds_read_b64_tr_b16 v[98:99], v7 offset:19456
  s_waitcnt lgkmcnt(3)
  v_mfma_f32_32x32x16_bf16 v[72:87], v[92:95], v[104:107], v[72:87]
  ds_read_b128 v[100:103], v9 offset:2048
  ds_read_b64_tr_b16 v[88:89], v7 offset:20480
  ds_read_b64_tr_b16 v[90:91], v7 offset:21504
  s_waitcnt lgkmcnt(3)
  v_mfma_f32_32x32x16_bf16 v[72:87], v[96:99], v[108:111], v[72:87]
  ds_read_b128 v[104:107], v9 offset:3072
  ds_read_b64_tr_b16 v[92:93], v7 offset:22528
  ds_read_b64_tr_b16 v[94:95], v7 offset:23552
  s_waitcnt lgkmcnt(3)
  v_mfma_f32_32x32x16_bf16 v[72:87], v[88:91], v[100:103], v[72:87]
  ds_read_b128 v[108:111], v9 offset:4096
  ds_read_b64_tr_b16 v[96:97], v7 offset:24576
  ds_read_b64_tr_b16 v[98:99], v7 offset:25600
  s_waitcnt lgkmcnt(3)
  v_mfma_f32_32x32x16_bf16 v[72:87], v[92:95], v[104:107], v[72:87]
  ds_read_b128 v[100:103], v9 offset:5120
  ds_read_b64_tr_b16 v[88:89], v7 offset:26624
  ds_read_b64_tr_b16 v[90:91], v7 offset:27648
  s_waitcnt lgkmcnt(3)
  v_mfma_f32_32x32x16_bf16 v[72:87], v[96:99], v[108:111], v[72:87]
  ds_read_b128 v[104:107], v9 offset:6144
  ds_read_b64_tr_b16 v[92:93], v7 offset:28672
  ds_read_b64_tr_b16 v[94:95], v7 offset:29696
  s_waitcnt lgkmcnt(3)
  v_mfma_f32_32x32x16_bf16 v[72:87], v[88:91], v[100:103], v[72:87]
  ds_read_b128 v[108:111], v9 offset:7168
  ds_read_b64_tr_b16 v[96:97], v7 offset:30720
  ds_read_b64_tr_b16 v[98:99], v7 offset:31744
  s_waitcnt lgkmcnt(3)
  v_mfma_f32_32x32x16_bf16 v[72:87], v[92:95], v[104:107], v[72:87]
  s_waitcnt lgkmcnt(0)
  s_barrier
  ds_read_b128 v[100:103], v9 offset:16384
  ds_read_b64_tr_b16 v[88:89], v7 offset:32768
  ds_read_b64_tr_b16 v[90:91], v7 offset:33792
  v_mfma_f32_32x32x16_bf16 v[72:87], v[96:99], v[108:111], v[72:87]
  ds_read_b128 v[104:107], v9 offset:17408
  ds_read_b64_tr_b16 v[92:93], v7 offset:34816
  ds_read_b64_tr_b16 v[94:95], v7 offset:35840
  s_waitcnt lgkmcnt(3)
  v_mfma_f32_32x32x16_bf16 v[72:87], v[88:91], v[100:103], v[72:87]
  ds_read_b128 v[108:111], v9 offset:18432
  ds_read_b64_tr_b16 v[96:97], v7 offset:36864
  ds_read_b64_tr_b16 v[98:99], v7 offset:37888
  s_waitcnt lgkmcnt(3)
  v_mfma_f32_32x32x16_bf16 v[72:87], v[92:95], v[104:107], v[72:87]
  ds_read_b128 v[100:103], v9 offset:19456
  ds_read_b64_tr_b16 v[88:89], v7 offset:38912
  ds_read_b64_tr_b16 v[90:91], v7 offset:39936
  s_waitcnt lgkmcnt(3)
  v_mfma_f32_32x32x16_bf16 v[72:87], v[96:99], v[108:111], v[72:87]
  s_waitcnt lgkmcnt(0)
  v_mfma_f32_32x32x16_bf16 v[72:87], v[88:91], v[100:103], v[72:87]
  s_barrier
  ds_read_b128 v[100:103], v9 offset:49152
  ds_read_b64_tr_b16 v[88:89], v6 offset:32768
  ds_read_b64_tr_b16 v[90:91], v6 offset:33792
  ds_read_b128 v[104:107], v9 offset:50176
  ds_read_b64_tr_b16 v[92:93], v6 offset:34816
  ds_read_b64_tr_b16 v[94:95], v6 offset:35840
  s_waitcnt lgkmcnt(3)
  v_mfma_f32_32x32x16_bf16 v[72:87], v[88:91], v[100:103], v[72:87]
  ds_read_b128 v[108:111], v9 offset:51200
  ds_read_b64_tr_b16 v[96:97], v6 offset:36864
  ds_read_b64_tr_b16 v[98:99], v6 offset:37888
  s_waitcnt lgkmcnt(3)
  v_mfma_f32_32x32x16_bf16 v[72:87], v[92:95], v[104:107], v[72:87]
  ds_read_b128 v[100:103], v9 offset:52224
  ds_read_b64_tr_b16 v[88:89], v6 offset:38912
  ds_read_b64_tr_b16 v[90:91], v6 offset:39936
  s_waitcnt lgkmcnt(3)
  v_mfma_f32_32x32x16_bf16 v[72:87], v[96:99], v[108:111], v[72:87]
  ds_read_b128 v[104:107], v9 offset:53248
  ds_read_b64_tr_b16 v[92:93], v6 offset:40960
  ds_read_b64_tr_b16 v[94:95], v6 offset:41984
  s_waitcnt lgkmcnt(3)
  v_mfma_f32_32x32x16_bf16 v[72:87], v[88:91], v[100:103], v[72:87]
  ds_read_b128 v[108:111], v9 offset:54272
  ds_read_b64_tr_b16 v[96:97], v6 offset:43008
  ds_read_b64_tr_b16 v[98:99], v6 offset:44032
  s_waitcnt lgkmcnt(3)
  v_mfma_f32_32x32x16_bf16 v[72:87], v[92:95], v[104:107], v[72:87]
  ds_read_b128 v[100:103], v9 offset:55296
  ds_read_b64_tr_b16 v[88:89], v6 offset:45056
  ds_read_b64_tr_b16 v[90:91], v6 offset:46080
  s_waitcnt lgkmcnt(3)
  v_mfma_f32_32x32x16_bf16 v[72:87], v[96:99], v[108:111], v[72:87]
  ds_read_b128 v[104:107], v9 offset:56320
  ds_read_b64_tr_b16 v[92:93], v6 offset:47104
  ds_read_b64_tr_b16 v[94:95], v6 offset:48128
  s_waitcnt lgkmcnt(3)
  v_mfma_f32_32x32x16_bf16 v[72:87], v[88:91], v[100:103], v[72:87]
  s_waitcnt lgkmcnt(0)
  s_barrier
  ds_read_b128 v[108:111], v10 offset:0
  ds_read_b64_tr_b16 v[96:97], v7 offset:49152
  ds_read_b64_tr_b16 v[98:99], v7 offset:50176
  v_mfma_f32_32x32x16_bf16 v[72:87], v[92:95], v[104:107], v[72:87]
  ds_read_b128 v[100:103], v10 offset:1024
  ds_read_b64_tr_b16 v[88:89], v7 offset:51200
  ds_read_b64_tr_b16 v[90:91], v7 offset:52224
  s_waitcnt lgkmcnt(3)
  v_mfma_f32_32x32x16_bf16 v[72:87], v[96:99], v[108:111], v[72:87]
  ds_read_b128 v[104:107], v10 offset:2048
  ds_read_b64_tr_b16 v[92:93], v7 offset:53248
  ds_read_b64_tr_b16 v[94:95], v7 offset:54272
  s_waitcnt lgkmcnt(3)
  v_mfma_f32_32x32x16_bf16 v[72:87], v[88:91], v[100:103], v[72:87]
  ds_read_b128 v[108:111], v10 offset:3072
  ds_read_b64_tr_b16 v[96:97], v7 offset:55296
  ds_read_b64_tr_b16 v[98:99], v7 offset:56320
  s_waitcnt lgkmcnt(3)
  v_mfma_f32_32x32x16_bf16 v[72:87], v[92:95], v[104:107], v[72:87]
  ds_read_b128 v[100:103], v10 offset:4096
  ds_read_b64_tr_b16 v[88:89], v7 offset:57344
  ds_read_b64_tr_b16 v[90:91], v7 offset:58368
  s_waitcnt lgkmcnt(3)
  v_mfma_f32_32x32x16_bf16 v[72:87], v[96:99], v[108:111], v[72:87]
  ds_read_b128 v[104:107], v10 offset:5120
  ds_read_b64_tr_b16 v[92:93], v7 offset:59392
  ds_read_b64_tr_b16 v[94:95], v7 offset:60416
  s_waitcnt lgkmcnt(3)
  v_mfma_f32_32x32x16_bf16 v[72:87], v[88:91], v[100:103], v[72:87]
  ds_read_b128 v[108:111], v10 offset:6144
  ds_read_b64_tr_b16 v[96:97], v7 offset:61440
  ds_read_b64_tr_b16 v[98:99], v7 offset:62464
  s_waitcnt lgkmcnt(3)
  v_mfma_f32_32x32x16_bf16 v[72:87], v[92:95], v[104:107], v[72:87]
  ds_read_b128 v[100:103], v10 offset:7168
  ds_read_b64_tr_b16 v[88:89], v7 offset:63488
  ds_read_b64_tr_b16 v[90:91], v7 offset:64512
  s_waitcnt lgkmcnt(3)
  v_mfma_f32_32x32x16_bf16 v[72:87], v[96:99], v[108:111], v[72:87]
  s_waitcnt lgkmcnt(0)
  s_barrier
  ds_read_b128 v[104:107], v10 offset:16384
  ds_read_b64_tr_b16 v[92:93], v8 offset:0
  ds_read_b64_tr_b16 v[94:95], v8 offset:1024
  v_mfma_f32_32x32x16_bf16 v[72:87], v[88:91], v[100:103], v[72:87]
  ds_read_b128 v[108:111], v10 offset:17408
  ds_read_b64_tr_b16 v[96:97], v8 offset:2048
  ds_read_b64_tr_b16 v[98:99], v8 offset:3072
  s_waitcnt lgkmcnt(3)
  v_mfma_f32_32x32x16_bf16 v[72:87], v[92:95], v[104:107], v[72:87]
  ds_read_b128 v[100:103], v10 offset:18432
  ds_read_b64_tr_b16 v[88:89], v8 offset:4096
  ds_read_b64_tr_b16 v[90:91], v8 offset:5120
  s_waitcnt lgkmcnt(3)
  v_mfma_f32_32x32x16_bf16 v[72:87], v[96:99], v[108:111], v[72:87]
  ds_read_b128 v[104:107], v10 offset:19456
  ds_read_b64_tr_b16 v[92:93], v8 offset:6144
  ds_read_b64_tr_b16 v[94:95], v8 offset:7168
  s_waitcnt lgkmcnt(3)
  v_mfma_f32_32x32x16_bf16 v[72:87], v[88:91], v[100:103], v[72:87]
  ds_read_b128 v[108:111], v10 offset:20480
  ds_read_b64_tr_b16 v[96:97], v8 offset:8192
  ds_read_b64_tr_b16 v[98:99], v8 offset:9216
  s_waitcnt lgkmcnt(3)
  v_mfma_f32_32x32x16_bf16 v[72:87], v[92:95], v[104:107], v[72:87]
  ds_read_b128 v[100:103], v10 offset:21504
  ds_read_b64_tr_b16 v[88:89], v8 offset:10240
  ds_read_b64_tr_b16 v[90:91], v8 offset:11264
  s_waitcnt lgkmcnt(3)
  v_mfma_f32_32x32x16_bf16 v[72:87], v[96:99], v[108:111], v[72:87]
  ds_read_b128 v[104:107], v10 offset:22528
  ds_read_b64_tr_b16 v[92:93], v8 offset:12288
  ds_read_b64_tr_b16 v[94:95], v8 offset:13312
  s_waitcnt lgkmcnt(3)
  v_mfma_f32_32x32x16_bf16 v[72:87], v[88:91], v[100:103], v[72:87]
  ds_read_b128 v[108:111], v10 offset:23552
  ds_read_b64_tr_b16 v[96:97], v8 offset:14336
  ds_read_b64_tr_b16 v[98:99], v8 offset:15360
  s_waitcnt lgkmcnt(3)
  v_mfma_f32_32x32x16_bf16 v[72:87], v[92:95], v[104:107], v[72:87]
  s_waitcnt lgkmcnt(0)
  s_barrier
  ds_read_b128 v[100:103], v10 offset:32768
  ds_read_b64_tr_b16 v[88:89], v6 offset:0
  ds_read_b64_tr_b16 v[90:91], v6 offset:1024
  v_mfma_f32_32x32x16_bf16 v[72:87], v[96:99], v[108:111], v[72:87]
  ds_read_b128 v[104:107], v10 offset:33792
  ds_read_b64_tr_b16 v[92:93], v6 offset:2048
  ds_read_b64_tr_b16 v[94:95], v6 offset:3072
  s_waitcnt lgkmcnt(3)
  v_mfma_f32_32x32x16_bf16 v[72:87], v[88:91], v[100:103], v[72:87]
  ds_read_b128 v[108:111], v10 offset:34816
  ds_read_b64_tr_b16 v[96:97], v6 offset:4096
  ds_read_b64_tr_b16 v[98:99], v6 offset:5120
  s_waitcnt lgkmcnt(3)
  v_mfma_f32_32x32x16_bf16 v[72:87], v[92:95], v[104:107], v[72:87]
  ds_read_b128 v[100:103], v10 offset:35840
  ds_read_b64_tr_b16 v[88:89], v6 offset:6144
  ds_read_b64_tr_b16 v[90:91], v6 offset:7168
  s_waitcnt lgkmcnt(3)
  v_mfma_f32_32x32x16_bf16 v[72:87], v[96:99], v[108:111], v[72:87]
  s_waitcnt lgkmcnt(0)
  v_mfma_f32_32x32x16_bf16 v[72:87], v[88:91], v[100:103], v[72:87]
  s_barrier
  ds_read_b128 v[100:103], v9 offset:32768
  ds_read_b64_tr_b16 v[88:89], v6 offset:16384
  ds_read_b64_tr_b16 v[90:91], v6 offset:17408
  ds_read_b128 v[104:107], v9 offset:33792
  ds_read_b64_tr_b16 v[92:93], v6 offset:18432
  ds_read_b64_tr_b16 v[94:95], v6 offset:19456
  s_waitcnt lgkmcnt(3)
  v_mfma_f32_32x32x16_bf16 v[72:87], v[88:91], v[100:103], v[72:87]
  ds_read_b128 v[108:111], v9 offset:34816
  ds_read_b64_tr_b16 v[96:97], v6 offset:20480
  ds_read_b64_tr_b16 v[98:99], v6 offset:21504
  s_waitcnt lgkmcnt(3)
  v_mfma_f32_32x32x16_bf16 v[72:87], v[92:95], v[104:107], v[72:87]
  ds_read_b128 v[100:103], v9 offset:35840
  ds_read_b64_tr_b16 v[88:89], v6 offset:22528
  ds_read_b64_tr_b16 v[90:91], v6 offset:23552
  s_waitcnt lgkmcnt(3)
  v_mfma_f32_32x32x16_bf16 v[72:87], v[96:99], v[108:111], v[72:87]
  ds_read_b128 v[104:107], v9 offset:36864
  ds_read_b64_tr_b16 v[92:93], v6 offset:24576
  ds_read_b64_tr_b16 v[94:95], v6 offset:25600
  s_waitcnt lgkmcnt(3)
  v_mfma_f32_32x32x16_bf16 v[72:87], v[88:91], v[100:103], v[72:87]
  ds_read_b128 v[108:111], v9 offset:37888
  ds_read_b64_tr_b16 v[96:97], v6 offset:26624
  ds_read_b64_tr_b16 v[98:99], v6 offset:27648
  s_waitcnt lgkmcnt(3)
  v_mfma_f32_32x32x16_bf16 v[72:87], v[92:95], v[104:107], v[72:87]
  ds_read_b128 v[100:103], v9 offset:38912
  ds_read_b64_tr_b16 v[88:89], v6 offset:28672
  ds_read_b64_tr_b16 v[90:91], v6 offset:29696
  s_waitcnt lgkmcnt(3)
  v_mfma_f32_32x32x16_bf16 v[72:87], v[96:99], v[108:111], v[72:87]
  ds_read_b128 v[104:107], v9 offset:39936
  ds_read_b64_tr_b16 v[92:93], v6 offset:30720
  ds_read_b64_tr_b16 v[94:95], v6 offset:31744
  s_waitcnt lgkmcnt(3)
  v_mfma_f32_32x32x16_bf16 v[72:87], v[88:91], v[100:103], v[72:87]
  s_waitcnt lgkmcnt(0)
  s_barrier
  ds_read_b128 v[108:111], v10 offset:49152
  ds_read_b64_tr_b16 v[96:97], v6 offset:49152
  ds_read_b64_tr_b16 v[98:99], v6 offset:50176
  v_mfma_f32_32x32x16_bf16 v[72:87], v[92:95], v[104:107], v[72:87]
  ds_read_b128 v[100:103], v10 offset:50176
  ds_read_b64_tr_b16 v[88:89], v6 offset:51200
  ds_read_b64_tr_b16 v[90:91], v6 offset:52224
  s_waitcnt lgkmcnt(3)
  v_mfma_f32_32x32x16_bf16 v[72:87], v[96:99], v[108:111], v[72:87]
  ds_read_b128 v[104:107], v10 offset:51200
  ds_read_b64_tr_b16 v[92:93], v6 offset:53248
  ds_read_b64_tr_b16 v[94:95], v6 offset:54272
  s_waitcnt lgkmcnt(3)
  v_mfma_f32_32x32x16_bf16 v[72:87], v[88:91], v[100:103], v[72:87]
  ds_read_b128 v[108:111], v10 offset:52224
  ds_read_b64_tr_b16 v[96:97], v6 offset:55296
  ds_read_b64_tr_b16 v[98:99], v6 offset:56320
  s_waitcnt lgkmcnt(3)
  v_mfma_f32_32x32x16_bf16 v[72:87], v[92:95], v[104:107], v[72:87]
  ds_read_b128 v[100:103], v10 offset:53248
  ds_read_b64_tr_b16 v[88:89], v6 offset:57344
  ds_read_b64_tr_b16 v[90:91], v6 offset:58368
  s_waitcnt lgkmcnt(3)
  v_mfma_f32_32x32x16_bf16 v[72:87], v[96:99], v[108:111], v[72:87]
  ds_read_b128 v[104:107], v10 offset:54272
  ds_read_b64_tr_b16 v[92:93], v6 offset:59392
  ds_read_b64_tr_b16 v[94:95], v6 offset:60416
  s_waitcnt lgkmcnt(3)
  v_mfma_f32_32x32x16_bf16 v[72:87], v[88:91], v[100:103], v[72:87]
  ds_read_b128 v[108:111], v10 offset:55296
  ds_read_b64_tr_b16 v[96:97], v6 offset:61440
  ds_read_b64_tr_b16 v[98:99], v6 offset:62464
  s_waitcnt lgkmcnt(3)
  v_mfma_f32_32x32x16_bf16 v[72:87], v[92:95], v[104:107], v[72:87]
  ds_read_b128 v[100:103], v10 offset:56320
  ds_read_b64_tr_b16 v[88:89], v6 offset:63488
  ds_read_b64_tr_b16 v[90:91], v6 offset:64512
  s_waitcnt lgkmcnt(3)
  v_mfma_f32_32x32x16_bf16 v[72:87], v[96:99], v[108:111], v[72:87]
  s_waitcnt lgkmcnt(0)
  s_barrier
  ds_read_b128 v[104:107], v11 offset:0
  ds_read_b64_tr_b16 v[92:93], v7 offset:0
  ds_read_b64_tr_b16 v[94:95], v7 offset:1024
  v_mfma_f32_32x32x16_bf16 v[72:87], v[88:91], v[100:103], v[72:87]
  ds_read_b128 v[108:111], v11 offset:1024
  ds_read_b64_tr_b16 v[96:97], v7 offset:2048
  ds_read_b64_tr_b16 v[98:99], v7 offset:3072
  s_waitcnt lgkmcnt(3)
  v_mfma_f32_32x32x16_bf16 v[72:87], v[92:95], v[104:107], v[72:87]
  ds_read_b128 v[100:103], v11 offset:2048
  ds_read_b64_tr_b16 v[88:89], v7 offset:4096
  ds_read_b64_tr_b16 v[90:91], v7 offset:5120
  s_waitcnt lgkmcnt(3)
  v_mfma_f32_32x32x16_bf16 v[72:87], v[96:99], v[108:111], v[72:87]
  ds_read_b128 v[104:107], v11 offset:3072
  ds_read_b64_tr_b16 v[92:93], v7 offset:6144
  ds_read_b64_tr_b16 v[94:95], v7 offset:7168
  s_waitcnt lgkmcnt(3)
  v_mfma_f32_32x32x16_bf16 v[72:87], v[88:91], v[100:103], v[72:87]
  ds_read_b128 v[108:111], v11 offset:4096
  ds_read_b64_tr_b16 v[96:97], v7 offset:8192
  ds_read_b64_tr_b16 v[98:99], v7 offset:9216
  s_waitcnt lgkmcnt(3)
  v_mfma_f32_32x32x16_bf16 v[72:87], v[92:95], v[104:107], v[72:87]
  ds_read_b128 v[100:103], v11 offset:5120
  ds_read_b64_tr_b16 v[88:89], v7 offset:10240
  ds_read_b64_tr_b16 v[90:91], v7 offset:11264
  s_waitcnt lgkmcnt(3)
  v_mfma_f32_32x32x16_bf16 v[72:87], v[96:99], v[108:111], v[72:87]
  ds_read_b128 v[104:107], v11 offset:6144
  ds_read_b64_tr_b16 v[92:93], v7 offset:12288
  ds_read_b64_tr_b16 v[94:95], v7 offset:13312
  s_waitcnt lgkmcnt(3)
  v_mfma_f32_32x32x16_bf16 v[72:87], v[88:91], v[100:103], v[72:87]
  ds_read_b128 v[108:111], v11 offset:7168
  ds_read_b64_tr_b16 v[96:97], v7 offset:14336
  ds_read_b64_tr_b16 v[98:99], v7 offset:15360
  s_waitcnt lgkmcnt(3)
  v_mfma_f32_32x32x16_bf16 v[72:87], v[92:95], v[104:107], v[72:87]
  s_waitcnt lgkmcnt(0)
  s_barrier
  ds_read_b128 v[100:103], v9 offset:0
  ds_read_b64_tr_b16 v[88:89], v7 offset:16384
  ds_read_b64_tr_b16 v[90:91], v7 offset:17408
  v_mfma_f32_32x32x16_bf16 v[72:87], v[96:99], v[108:111], v[72:87]
  ds_read_b128 v[104:107], v9 offset:1024
  ds_read_b64_tr_b16 v[92:93], v7 offset:18432
  ds_read_b64_tr_b16 v[94:95], v7 offset:19456
  s_waitcnt lgkmcnt(3)
  v_mfma_f32_32x32x16_bf16 v[72:87], v[88:91], v[100:103], v[72:87]
  ds_read_b128 v[108:111], v9 offset:2048
  ds_read_b64_tr_b16 v[96:97], v7 offset:20480
  ds_read_b64_tr_b16 v[98:99], v7 offset:21504
  s_waitcnt lgkmcnt(3)
  v_mfma_f32_32x32x16_bf16 v[72:87], v[92:95], v[104:107], v[72:87]
  ds_read_b128 v[100:103], v9 offset:3072
  ds_read_b64_tr_b16 v[88:89], v7 offset:22528
  ds_read_b64_tr_b16 v[90:91], v7 offset:23552
  s_waitcnt lgkmcnt(3)
  v_mfma_f32_32x32x16_bf16 v[72:87], v[96:99], v[108:111], v[72:87]
  ds_read_b128 v[104:107], v9 offset:4096
  ds_read_b64_tr_b16 v[92:93], v7 offset:24576
  ds_read_b64_tr_b16 v[94:95], v7 offset:25600
  s_waitcnt lgkmcnt(3)
  v_mfma_f32_32x32x16_bf16 v[72:87], v[88:91], v[100:103], v[72:87]
  ds_read_b128 v[108:111], v9 offset:5120
  ds_read_b64_tr_b16 v[96:97], v7 offset:26624
  ds_read_b64_tr_b16 v[98:99], v7 offset:27648
  s_waitcnt lgkmcnt(3)
  v_mfma_f32_32x32x16_bf16 v[72:87], v[92:95], v[104:107], v[72:87]
  ds_read_b128 v[100:103], v9 offset:6144
  ds_read_b64_tr_b16 v[88:89], v7 offset:28672
  ds_read_b64_tr_b16 v[90:91], v7 offset:29696
  s_waitcnt lgkmcnt(3)
  v_mfma_f32_32x32x16_bf16 v[72:87], v[96:99], v[108:111], v[72:87]
  ds_read_b128 v[104:107], v9 offset:7168
  ds_read_b64_tr_b16 v[92:93], v7 offset:30720
  ds_read_b64_tr_b16 v[94:95], v7 offset:31744
  s_waitcnt lgkmcnt(3)
  v_mfma_f32_32x32x16_bf16 v[72:87], v[88:91], v[100:103], v[72:87]
  s_waitcnt lgkmcnt(0)
  v_mfma_f32_32x32x16_bf16 v[72:87], v[92:95], v[104:107], v[72:87]
  v_lshlrev_b32 v88, 16, v32
  v_and_b32 v89, s75, v32
  v_lshlrev_b32 v104, 16, v40
  v_and_b32 v105, s75, v40
  v_lshlrev_b32 v90, 16, v33
  v_and_b32 v91, s75, v33
  v_lshlrev_b32 v106, 16, v41
  v_and_b32 v107, s75, v41
  v_lshlrev_b32 v92, 16, v34
  v_and_b32 v93, s75, v34
  v_lshlrev_b32 v108, 16, v42
  v_and_b32 v109, s75, v42
  v_lshlrev_b32 v94, 16, v35
  v_and_b32 v95, s75, v35
  v_lshlrev_b32 v110, 16, v43
  v_and_b32 v111, s75, v43
  v_lshlrev_b32 v96, 16, v36
  v_and_b32 v97, s75, v36
  v_lshlrev_b32 v112, 16, v44
  v_and_b32 v113, s75, v44
  v_lshlrev_b32 v98, 16, v37
  v_and_b32 v99, s75, v37
  v_lshlrev_b32 v114, 16, v45
  v_and_b32 v115, s75, v45
  v_lshlrev_b32 v100, 16, v38
  v_and_b32 v101, s75, v38
  v_lshlrev_b32 v116, 16, v46
  v_and_b32 v117, s75, v46
  v_lshlrev_b32 v102, 16, v39
  v_and_b32 v103, s75, v39
  v_lshlrev_b32 v118, 16, v47
  v_and_b32 v119, s75, v47
  v_pk_add_f32 v[88:89], v[88:89], v[104:105]
  v_pk_add_f32 v[90:91], v[90:91], v[106:107]
  v_pk_add_f32 v[92:93], v[92:93], v[108:109]
  v_pk_add_f32 v[94:95], v[94:95], v[110:111]
  v_pk_add_f32 v[96:97], v[96:97], v[112:113]
  v_pk_add_f32 v[98:99], v[98:99], v[114:115]
  v_pk_add_f32 v[100:101], v[100:101], v[116:117]
  v_pk_add_f32 v[102:103], v[102:103], v[118:119]
  v_pk_add_f32 v[72:73], v[72:73], v[88:89]
  v_pk_add_f32 v[74:75], v[74:75], v[90:91]
  v_pk_add_f32 v[76:77], v[76:77], v[92:93]
  v_pk_add_f32 v[78:79], v[78:79], v[94:95]
  v_pk_add_f32 v[80:81], v[80:81], v[96:97]
  v_pk_add_f32 v[82:83], v[82:83], v[98:99]
  v_pk_add_f32 v[84:85], v[84:85], v[100:101]
  v_pk_add_f32 v[86:87], v[86:87], v[102:103]
  v_cvt_pk_bf16_f32 v120, v72, v73
  v_cvt_pk_bf16_f32 v121, v74, v75
  v_cvt_pk_bf16_f32 v122, v76, v77
  v_cvt_pk_bf16_f32 v123, v78, v79
  v_cvt_pk_bf16_f32 v124, v80, v81
  v_cvt_pk_bf16_f32 v125, v82, v83
  v_cvt_pk_bf16_f32 v126, v84, v85
  v_cvt_pk_bf16_f32 v127, v86, v87
  s_nop 1
  v_permlane32_swap_b32 v120, v122
  v_permlane32_swap_b32 v121, v123
  v_permlane32_swap_b32 v124, v126
  v_permlane32_swap_b32 v125, v127
  s_nop 0
  buffer_store_dwordx4 v[120:123], v15, s[32:35], 0 offen offset:0
  buffer_store_dwordx4 v[124:127], v15, s[32:35], 0 offen offset:32
  s_endpgm
Lexit:
  s_endpgm
Lcode_end:
.section .rodata,"a"
.p2align 6
.amdhsa_kernel parallel_sum__linear_attn_block__mixer_s_mlp__prompt_kernel
  .amdhsa_next_free_vgpr 256
  .amdhsa_next_free_sgpr 102
  .amdhsa_accum_offset 128
  .amdhsa_group_segment_fixed_size 0
  .amdhsa_kernarg_size 88
  .amdhsa_user_sgpr_count 2
  .amdhsa_user_sgpr_kernarg_segment_ptr 1
  .amdhsa_system_sgpr_workgroup_id_x 1
  .amdhsa_float_denorm_mode_32 3
.end_amdhsa_kernel
```
